```python
import torch

def _softmax(x, axis=-1):
    return torch.softmax(x, dim=axis)
def _gelu(x):
    return torch.nn.functional.gelu(x, approximate="tanh")
def _silu(x):
    return torch.nn.functional.silu(x)
def _sigmoid(x):
    return torch.sigmoid(x)
def _layernorm(x, axis=-1, eps=1e-5):
    m = x.mean(dim=axis, keepdim=True)
    v = x.var(dim=axis, keepdim=True, unbiased=False)
    return (x - m) / torch.sqrt(v + eps)
def _scatter_add(tgt, idx, src, axis=0):
    return tgt.clone().index_add_(axis, idx, src)
def _segment_sum(src, seg, n):
    out = torch.zeros((n,) + src.shape[1:], dtype=src.dtype)
    return out.index_add_(0, seg, src)
def _pad(x, pw):
    flat = tuple(v for pair in reversed(pw) for v in pair)
    return torch.nn.functional.pad(x, flat)

kernel_name = 'standalone__gqa_softmax__near_ridge'

def setup_inputs():

    _w = (lambda a: (lambda t: t.to(torch.bfloat16) if t.is_floating_point() else t)(torch.as_tensor(a)))
    B, Hq, Hkv, Sq, Sk, D = 8, 16, 8, 128, 2048, 256
    return {
        "q": _w((lambda *s: torch.randn(*s, dtype=torch.bfloat16) * 0.8)(B, Hq, Sq, D)),
        "k": _w((lambda *s: torch.randn(*s, dtype=torch.bfloat16) * 0.8)(B, Hkv, Sk, D)),
        "v": _w((lambda *s: torch.randn(*s, dtype=torch.bfloat16) * 0.05)(B, Hkv, Sk, D)),
    }

def reference(q, k, v):
    B, Hq, Sq, D = q.shape
    Hkv = k.shape[1]
    rep = Hq // Hkv
    k = (lambda x, n, axis: torch.repeat_interleave(x, n, dim=axis))(k, rep, axis=1)
    v = (lambda x, n, axis: torch.repeat_interleave(x, n, dim=axis))(v, rep, axis=1)
    scale = D ** -0.5
    scores = torch.einsum("bhqd,bhkd->bhqk", q, k) * scale
    p = _softmax(scores, axis=-1)
    return torch.einsum("bhqk,bhkd->bhqd", p, v)
```

```asm
; @launch grid=(256,1,1) block=(256,1,1) lds=163840
.amdgcn_target "amdgcn-amd-amdhsa--gfx950"

.text
.globl standalone__gqa_softmax__near_ridge_kernel
.p2align 8
.type standalone__gqa_softmax__near_ridge_kernel,@function
standalone__gqa_softmax__near_ridge_kernel:
    s_cmp_ge_u32 s2, 256
    s_cbranch_scc1 L_done
    s_load_dwordx4 s[40:43], s[0:1], 0
    s_load_dwordx4 s[44:47], s[0:1], 16
    s_load_dwordx2 s[88:89], s[0:1], 40
    s_memrealtime s[38:39]
    v_lshrrev_b32 v1, 6, v0
    v_and_b32 v0, 63, v0
    v_readfirstlane_b32 s20, v1
    s_and_b32 s48, s2, 7
    s_lshr_b32 s49, s2, 3
    s_getpc_b64 s[96:97]
L_pc:
    s_sub_u32 s96, s96, L_pc-standalone__gqa_softmax__near_ridge_kernel
    s_subb_u32 s97, s97, 0
    s_mov_b32 s98, L_codeend-standalone__gqa_softmax__near_ridge_kernel
    s_mov_b32 s99, 0x20000
    s_lshl_b32 s58, s49, 2
    s_add_u32 s58, s58, s20
    s_lshl_b32 s58, s58, 9
    v_lshlrev_b32 v46, 3, v0
    buffer_load_dwordx2 v[242:243], v46, s[96:99], s58 offen
    s_lshr_b32 s50, s49, 2
    s_lshl_b32 s48, s48, 3
    s_add_u32 s50, s50, s48
    s_and_b32 s51, s49, 1
    s_bfe_u32 s35, s49, 0x10001
    v_lshrrev_b32 v44, 5, v0
    v_and_b32 v45, 31, v0
    v_add_u32 v46, 0, v44
    v_xor_b32 v46, v46, v45
    v_lshlrev_b32 v46, 4, v46
    v_lshl_add_u32 v2, v44, 9, v46
    v_add_u32 v46, 2, v44
    v_xor_b32 v46, v46, v45
    v_lshlrev_b32 v46, 4, v46
    v_lshl_add_u32 v3, v44, 9, v46
    v_add_u32 v46, 4, v44
    v_xor_b32 v46, v46, v45
    v_lshlrev_b32 v46, 4, v46
    v_lshl_add_u32 v4, v44, 9, v46
    v_add_u32 v46, 6, v44
    v_xor_b32 v46, v46, v45
    v_lshlrev_b32 v46, 4, v46
    v_lshl_add_u32 v5, v44, 9, v46
    v_add_u32 v46, 8, v44
    v_xor_b32 v46, v46, v45
    v_lshlrev_b32 v46, 4, v46
    v_lshl_add_u32 v6, v44, 9, v46
    v_add_u32 v46, 10, v44
    v_xor_b32 v46, v46, v45
    v_lshlrev_b32 v46, 4, v46
    v_lshl_add_u32 v7, v44, 9, v46
    v_add_u32 v46, 12, v44
    v_xor_b32 v46, v46, v45
    v_lshlrev_b32 v46, 4, v46
    v_lshl_add_u32 v8, v44, 9, v46
    v_add_u32 v46, 14, v44
    v_xor_b32 v46, v46, v45
    v_lshlrev_b32 v46, 4, v46
    v_lshl_add_u32 v9, v44, 9, v46
    v_lshrrev_b32 v46, 4, v0
    v_and_b32 v47, 7, v0
    v_xor_b32 v46, v46, v47
    v_lshlrev_b32 v46, 4, v46
    v_lshrrev_b32 v47, 3, v0
    v_lshl_add_u32 v42, v47, 9, v46
    v_xor_b32 v43, 64, v42
    s_lshl_b32 s53, s50, 1
    s_add_u32 s53, s53, s51
    s_lshl_b32 s52, s53, 1
    s_add_u32 s52, s52, s35
    s_lshl_b32 s53, s53, 16
    s_lshl_b32 s54, s50, 20
    s_mul_i32 s55, s35, 524288
    s_add_u32 s54, s54, s55
    s_lshl_b32 s34, s20, 13
    s_lshl_b32 s56, s20, 14
    s_add_u32 s57, s56, 98304
    s_mov_b32 s6, 65536
    s_mov_b32 s7, 0x20000
    s_mov_b32 s10, 524288
    s_mov_b32 s11, 0x20000
    s_mov_b32 s23, s34
    s_mov_b32 s24, s34
    s_mov_b32 s26, s34
    s_add_u32 m0, s57, 0
    s_waitcnt lgkmcnt(0)
    s_add_u32 s4, s40, s53
    s_addc_u32 s5, s41, 0
    s_add_u32 s8, s42, s54
    s_addc_u32 s9, s43, 0
    buffer_load_dwordx4 v42, s[4:7], s56 offen lds
    s_add_u32 m0, s57, 1024
    s_add_u32 s58, s56, 4096
    buffer_load_dwordx4 v43, s[4:7], s58 offen lds
    s_add_u32 m0, s57, 2048
    s_add_u32 s58, s56, 8192
    buffer_load_dwordx4 v42, s[4:7], s58 offen lds
    s_add_u32 m0, s57, 3072
    s_add_u32 s58, s56, 12288
    buffer_load_dwordx4 v43, s[4:7], s58 offen lds
    s_mov_b32 s14, 524288
    s_mov_b32 s15, 0x20000
    s_mov_b32 s18, 65536
    s_mov_b32 s19, 0x20000
    s_mov_b32 s90, 0x10000000
    s_mov_b32 s91, 0x20000
    s_add_u32 s12, s44, s54
    s_addc_u32 s13, s45, 0
    s_add_u32 s16, s46, s53
    s_addc_u32 s17, s47, 0
    s_lshl_b32 s52, s52, 2
    s_add_u32 s52, s52, s20
    s_xor_b32 s51, s52, 4
    s_mul_i32 s92, s52, 2048
    s_mul_i32 s93, s51, 2048
    s_add_u32 s94, s92, 1024
    s_add_u32 s95, s93, 1024
    s_getreg_b32 s39, hwreg(HW_REG_XCC_ID, 0, 4)
    s_lshl_b32 s38, s38, 4
    s_or_b32 s27, s38, s39
    v_mov_b32 v240, s27
    s_mov_b32 s66, 0xffff0000
    s_mov_b32 s67, 0xffff0000
    s_add_u32 m0, s57, 4096
    s_add_u32 s58, s56, 128
    buffer_load_dwordx4 v42, s[4:7], s58 offen lds
    s_lshl_b32 s59, s35, 8
    v_add_u32 v46, 0, v44
    v_lshlrev_b32 v46, 1, v46
    v_xor_b32 v46, v46, v45
    v_lshlrev_b32 v46, 4, v46
    v_xor_b32 v46, s59, v46
    v_lshl_add_u32 v10, v44, 9, v46
    v_add_u32 v46, 2, v44
    v_lshlrev_b32 v46, 1, v46
    v_xor_b32 v46, v46, v45
    v_lshlrev_b32 v46, 4, v46
    v_xor_b32 v46, s59, v46
    v_lshl_add_u32 v11, v44, 9, v46
    v_add_u32 v46, 4, v44
    v_lshlrev_b32 v46, 1, v46
    v_xor_b32 v46, v46, v45
    v_lshlrev_b32 v46, 4, v46
    v_xor_b32 v46, s59, v46
    v_lshl_add_u32 v12, v44, 9, v46
    v_add_u32 v46, 6, v44
    s_add_u32 m0, s57, 5120
    s_add_u32 s58, s56, 4224
    buffer_load_dwordx4 v43, s[4:7], s58 offen lds
    v_lshlrev_b32 v46, 1, v46
    v_xor_b32 v46, v46, v45
    v_lshlrev_b32 v46, 4, v46
    v_xor_b32 v46, s59, v46
    v_lshl_add_u32 v13, v44, 9, v46
    v_and_b32 v45, 15, v0
    v_lshrrev_b32 v44, 4, v0
    v_xor_b32 v46, v44, v45
    v_lshlrev_b32 v46, 4, v46
    v_xor_b32 v47, 0, v46
    v_lshl_add_u32 v14, v45, 9, v47
    v_xor_b32 v47, 64, v46
    v_lshl_add_u32 v15, v45, 9, v47
    v_xor_b32 v47, 128, v46
    v_lshl_add_u32 v16, v45, 9, v47
    v_xor_b32 v47, 192, v46
    v_lshl_add_u32 v17, v45, 9, v47
    v_lshrrev_b32 v44, 2, v0
    v_and_b32 v45, 3, v0
    v_lshlrev_b32 v45, 3, v45
    s_add_u32 m0, s57, 6144
    s_add_u32 s58, s56, 8320
    buffer_load_dwordx4 v42, s[4:7], s58 offen lds
    v_lshl_add_u32 v45, v44, 9, v45
    v_and_b32 v44, 7, v44
    v_xor_b32 v46, 0, v44
    v_lshl_add_u32 v22, v46, 5, v45
    v_xor_b32 v46, 1, v44
    v_lshl_add_u32 v23, v46, 5, v45
    v_xor_b32 v46, 2, v44
    v_lshl_add_u32 v24, v46, 5, v45
    v_xor_b32 v46, 3, v44
    v_lshl_add_u32 v25, v46, 5, v45
    v_xor_b32 v46, 4, v44
    v_lshl_add_u32 v26, v46, 5, v45
    v_xor_b32 v46, 5, v44
    v_lshl_add_u32 v27, v46, 5, v45
    v_xor_b32 v46, 6, v44
    v_lshl_add_u32 v28, v46, 5, v45
    v_xor_b32 v46, 7, v44
    v_lshl_add_u32 v29, v46, 5, v45
    s_mov_b32 s21, 0x3db8aa3b
    s_mov_b32 s78, 0x3db8aa3b
    s_add_u32 m0, s57, 7168
    s_add_u32 s58, s56, 12416
    buffer_load_dwordx4 v43, s[4:7], s58 offen lds
    s_mov_b32 s79, 0x3db8aa3b
    s_mov_b32 s22, 0x41f00000
    v_mov_b32 v47, 0x3f803f80
    s_mov_b32 s25, 65536
    v_lshlrev_b32 v241, 4, v0
    v_lshrrev_b32 v46, 4, v0
    v_and_b32 v1, 0xf0, v241
    v_lshl_add_u32 v1, v46, 9, v1
    s_lshl_b32 s72, s20, 14
    s_add_u32 s72, s72, s59
    s_xor_b32 s68, s72, 256
    s_add_u32 s73, s72, 4096
    s_add_u32 s69, s68, 4096
    s_add_u32 s74, s72, 8192
    s_add_u32 s70, s68, 8192
    s_add_u32 s75, s72, 12288
    s_add_u32 s71, s68, 12288
    v_add_u32 v18, s57, v14
    v_add_u32 v19, s57, v15
    v_add_u32 v20, s57, v16
    s_add_u32 m0, s57, 8192
    s_add_u32 s58, s56, 256
    buffer_load_dwordx4 v42, s[4:7], s58 offen lds
    v_add_u32 v21, s57, v17
    v_add_u32 v30, 65536, v22
    v_add_u32 v31, 65536, v23
    v_add_u32 v32, 65536, v24
    v_add_u32 v33, 65536, v25
    v_add_u32 v34, 65536, v26
    v_add_u32 v35, 65536, v27
    v_add_u32 v36, 65536, v28
    v_add_u32 v37, 65536, v29
    v_accvgpr_write_b32 a192, v47
    v_accvgpr_write_b32 a193, v47
    v_accvgpr_write_b32 a194, v47
    v_accvgpr_write_b32 a195, v47
    v_accvgpr_write_b32 a196, 0
    v_accvgpr_write_b32 a197, 0
    v_accvgpr_write_b32 a198, 0
    v_accvgpr_write_b32 a199, 0
    v_accvgpr_write_b32 a200, 0
    v_accvgpr_write_b32 a201, 0
    v_accvgpr_write_b32 a202, 0
    s_add_u32 m0, s57, 9216
    s_add_u32 s58, s56, 4352
    buffer_load_dwordx4 v43, s[4:7], s58 offen lds
    v_accvgpr_write_b32 a203, 0
    v_accvgpr_write_b32 a0, 0
    v_accvgpr_write_b32 a1, 0
    v_accvgpr_write_b32 a2, 0
    v_accvgpr_write_b32 a3, 0
    v_accvgpr_write_b32 a4, 0
    v_accvgpr_write_b32 a5, 0
    v_accvgpr_write_b32 a6, 0
    v_accvgpr_write_b32 a7, 0
    v_accvgpr_write_b32 a8, 0
    v_accvgpr_write_b32 a9, 0
    v_accvgpr_write_b32 a10, 0
    v_accvgpr_write_b32 a11, 0
    v_accvgpr_write_b32 a12, 0
    v_accvgpr_write_b32 a13, 0
    v_accvgpr_write_b32 a14, 0
    v_accvgpr_write_b32 a15, 0
    v_accvgpr_write_b32 a16, 0
    v_accvgpr_write_b32 a17, 0
    v_accvgpr_write_b32 a18, 0
    s_add_u32 m0, s57, 10240
    s_add_u32 s58, s56, 8448
    buffer_load_dwordx4 v42, s[4:7], s58 offen lds
    v_accvgpr_write_b32 a19, 0
    v_accvgpr_write_b32 a20, 0
    v_accvgpr_write_b32 a21, 0
    v_accvgpr_write_b32 a22, 0
    v_accvgpr_write_b32 a23, 0
    v_accvgpr_write_b32 a24, 0
    v_accvgpr_write_b32 a25, 0
    v_accvgpr_write_b32 a26, 0
    v_accvgpr_write_b32 a27, 0
    v_accvgpr_write_b32 a28, 0
    v_accvgpr_write_b32 a29, 0
    v_accvgpr_write_b32 a30, 0
    v_accvgpr_write_b32 a31, 0
    v_accvgpr_write_b32 a32, 0
    v_accvgpr_write_b32 a33, 0
    v_accvgpr_write_b32 a34, 0
    v_accvgpr_write_b32 a35, 0
    v_accvgpr_write_b32 a36, 0
    v_accvgpr_write_b32 a37, 0
    v_accvgpr_write_b32 a38, 0
    s_add_u32 m0, s57, 11264
    s_add_u32 s58, s56, 12544
    buffer_load_dwordx4 v43, s[4:7], s58 offen lds
    v_accvgpr_write_b32 a39, 0
    v_accvgpr_write_b32 a40, 0
    v_accvgpr_write_b32 a41, 0
    v_accvgpr_write_b32 a42, 0
    v_accvgpr_write_b32 a43, 0
    v_accvgpr_write_b32 a44, 0
    v_accvgpr_write_b32 a45, 0
    v_accvgpr_write_b32 a46, 0
    v_accvgpr_write_b32 a47, 0
    v_accvgpr_write_b32 a48, 0
    v_accvgpr_write_b32 a49, 0
    v_accvgpr_write_b32 a50, 0
    v_accvgpr_write_b32 a51, 0
    v_accvgpr_write_b32 a52, 0
    v_accvgpr_write_b32 a53, 0
    v_accvgpr_write_b32 a54, 0
    v_accvgpr_write_b32 a55, 0
    v_accvgpr_write_b32 a56, 0
    v_accvgpr_write_b32 a57, 0
    v_accvgpr_write_b32 a58, 0
    s_add_u32 m0, s57, 12288
    s_add_u32 s58, s56, 384
    buffer_load_dwordx4 v42, s[4:7], s58 offen lds
    v_accvgpr_write_b32 a59, 0
    v_accvgpr_write_b32 a60, 0
    v_accvgpr_write_b32 a61, 0
    v_accvgpr_write_b32 a62, 0
    v_accvgpr_write_b32 a63, 0
    v_mov_b32 v128, 0
    v_mov_b32 v129, 0
    v_mov_b32 v130, 0
    v_mov_b32 v131, 0
    v_mov_b32 v132, 0
    v_mov_b32 v133, 0
    v_mov_b32 v134, 0
    v_mov_b32 v135, 0
    v_mov_b32 v136, 0
    v_mov_b32 v137, 0
    v_mov_b32 v138, 0
    v_mov_b32 v139, 0
    v_mov_b32 v140, 0
    v_mov_b32 v141, 0
    v_mov_b32 v142, 0
    s_add_u32 m0, s57, 13312
    s_add_u32 s58, s56, 4480
    buffer_load_dwordx4 v43, s[4:7], s58 offen lds
    v_mov_b32 v143, 0
    v_mov_b32 v144, 0
    v_mov_b32 v145, 0
    v_mov_b32 v146, 0
    v_mov_b32 v147, 0
    v_mov_b32 v148, 0
    v_mov_b32 v149, 0
    v_mov_b32 v150, 0
    v_mov_b32 v151, 0
    v_mov_b32 v152, 0
    v_mov_b32 v153, 0
    v_mov_b32 v154, 0
    v_mov_b32 v155, 0
    v_mov_b32 v156, 0
    v_mov_b32 v157, 0
    v_mov_b32 v158, 0
    v_mov_b32 v159, 0
    v_mov_b32 v160, 0
    v_mov_b32 v161, 0
    v_mov_b32 v162, 0
    s_add_u32 m0, s57, 14336
    s_add_u32 s58, s56, 8576
    buffer_load_dwordx4 v42, s[4:7], s58 offen lds
    v_mov_b32 v163, 0
    v_mov_b32 v164, 0
    v_mov_b32 v165, 0
    v_mov_b32 v166, 0
    v_mov_b32 v167, 0
    v_mov_b32 v168, 0
    v_mov_b32 v169, 0
    v_mov_b32 v170, 0
    v_mov_b32 v171, 0
    v_mov_b32 v172, 0
    v_mov_b32 v173, 0
    v_mov_b32 v174, 0
    v_mov_b32 v175, 0
    v_mov_b32 v176, 0
    v_mov_b32 v177, 0
    v_mov_b32 v178, 0
    v_mov_b32 v179, 0
    v_mov_b32 v180, 0
    v_mov_b32 v181, 0
    v_mov_b32 v182, 0
    s_add_u32 m0, s57, 15360
    s_add_u32 s58, s56, 12672
    buffer_load_dwordx4 v43, s[4:7], s58 offen lds
    v_mov_b32 v183, 0
    v_mov_b32 v184, 0
    v_mov_b32 v185, 0
    v_mov_b32 v186, 0
    v_mov_b32 v187, 0
    v_mov_b32 v188, 0
    v_mov_b32 v189, 0
    v_mov_b32 v190, 0
    v_mov_b32 v191, 0
    v_and_b32 v44, 15, v0
    v_lshrrev_b32 v45, 4, v0
    v_lshrrev_b32 v46, 1, v44
    v_xor_b32 v45, v45, v46
    v_lshlrev_b32 v45, 4, v45
    v_and_b32 v46, 7, v44
    v_lshl_add_u32 v45, v46, 7, v45
    v_lshrrev_b32 v46, 3, v44
    v_lshl_add_u32 v45, v46, 10, v45
    v_add_u32 v244, s57, v45
    v_xor_b32 v245, 64, v244
    s_waitcnt vmcnt(12)
    ds_read_b128 v[48:51], v244 offset:0
    ds_read_b128 v[52:55], v244 offset:2048
    ds_read_b128 v[56:59], v245 offset:0
    ds_read_b128 v[60:63], v245 offset:2048
    s_mov_b32 m0, s26
    s_add_u32 s30, s23, 4096
    buffer_load_dwordx4 v2, s[8:11], s23 offen offset:0 nt lds
    s_waitcnt lgkmcnt(3)
    v_lshlrev_b32 v112, 16, v48
    v_and_b32 v113, 0xffff0000, v48
    v_lshlrev_b32 v114, 16, v49
    v_and_b32 v115, 0xffff0000, v49
    v_pk_mul_f32 v[112:113], v[112:113], s[78:79]
    v_pk_mul_f32 v[114:115], v[114:115], s[78:79]
    v_cvt_pk_bf16_f32 v48, v112, v113
    v_cvt_pk_bf16_f32 v49, v114, v115
    v_accvgpr_write_b32 a64, v48
    v_accvgpr_write_b32 a65, v49
    v_lshlrev_b32 v116, 16, v50
    v_and_b32 v117, 0xffff0000, v50
    v_lshlrev_b32 v118, 16, v51
    v_and_b32 v119, 0xffff0000, v51
    v_pk_mul_f32 v[116:117], v[116:117], s[78:79]
    v_pk_mul_f32 v[118:119], v[118:119], s[78:79]
    buffer_load_dwordx4 v3, s[8:11], s23 offen offset:1024 nt lds
    v_cvt_pk_bf16_f32 v50, v116, v117
    v_cvt_pk_bf16_f32 v51, v118, v119
    v_accvgpr_write_b32 a66, v50
    v_accvgpr_write_b32 a67, v51
    s_waitcnt lgkmcnt(2)
    v_lshlrev_b32 v120, 16, v52
    v_and_b32 v121, 0xffff0000, v52
    v_lshlrev_b32 v122, 16, v53
    v_and_b32 v123, 0xffff0000, v53
    v_pk_mul_f32 v[120:121], v[120:121], s[78:79]
    v_pk_mul_f32 v[122:123], v[122:123], s[78:79]
    v_cvt_pk_bf16_f32 v52, v120, v121
    v_cvt_pk_bf16_f32 v53, v122, v123
    v_accvgpr_write_b32 a68, v52
    v_accvgpr_write_b32 a69, v53
    v_lshlrev_b32 v124, 16, v54
    v_and_b32 v125, 0xffff0000, v54
    buffer_load_dwordx4 v4, s[8:11], s23 offen offset:2048 nt lds
    v_lshlrev_b32 v126, 16, v55
    v_and_b32 v127, 0xffff0000, v55
    v_pk_mul_f32 v[124:125], v[124:125], s[78:79]
    v_pk_mul_f32 v[126:127], v[126:127], s[78:79]
    v_cvt_pk_bf16_f32 v54, v124, v125
    v_cvt_pk_bf16_f32 v55, v126, v127
    v_accvgpr_write_b32 a70, v54
    v_accvgpr_write_b32 a71, v55
    s_waitcnt lgkmcnt(1)
    v_lshlrev_b32 v112, 16, v56
    v_and_b32 v113, 0xffff0000, v56
    v_lshlrev_b32 v114, 16, v57
    v_and_b32 v115, 0xffff0000, v57
    v_pk_mul_f32 v[112:113], v[112:113], s[78:79]
    v_pk_mul_f32 v[114:115], v[114:115], s[78:79]
    v_cvt_pk_bf16_f32 v56, v112, v113
    v_cvt_pk_bf16_f32 v57, v114, v115
    buffer_load_dwordx4 v5, s[8:11], s23 offen offset:3072 nt lds
    v_accvgpr_write_b32 a72, v56
    v_accvgpr_write_b32 a73, v57
    v_lshlrev_b32 v116, 16, v58
    v_and_b32 v117, 0xffff0000, v58
    v_lshlrev_b32 v118, 16, v59
    v_and_b32 v119, 0xffff0000, v59
    v_pk_mul_f32 v[116:117], v[116:117], s[78:79]
    v_pk_mul_f32 v[118:119], v[118:119], s[78:79]
    v_cvt_pk_bf16_f32 v58, v116, v117
    v_cvt_pk_bf16_f32 v59, v118, v119
    v_accvgpr_write_b32 a74, v58
    v_accvgpr_write_b32 a75, v59
    s_waitcnt lgkmcnt(0)
    v_lshlrev_b32 v120, 16, v60
    v_and_b32 v121, 0xffff0000, v60
    v_lshlrev_b32 v122, 16, v61
    v_and_b32 v123, 0xffff0000, v61
    s_add_u32 m0, s26, 4096
    s_add_u32 s23, s23, 32768
    buffer_load_dwordx4 v6, s[8:11], s30 offen offset:0 nt lds
    v_pk_mul_f32 v[120:121], v[120:121], s[78:79]
    v_pk_mul_f32 v[122:123], v[122:123], s[78:79]
    v_cvt_pk_bf16_f32 v60, v120, v121
    v_cvt_pk_bf16_f32 v61, v122, v123
    v_accvgpr_write_b32 a76, v60
    v_accvgpr_write_b32 a77, v61
    v_lshlrev_b32 v124, 16, v62
    v_and_b32 v125, 0xffff0000, v62
    v_lshlrev_b32 v126, 16, v63
    v_and_b32 v127, 0xffff0000, v63
    v_pk_mul_f32 v[124:125], v[124:125], s[78:79]
    v_pk_mul_f32 v[126:127], v[126:127], s[78:79]
    v_cvt_pk_bf16_f32 v62, v124, v125
    v_cvt_pk_bf16_f32 v63, v126, v127
    v_accvgpr_write_b32 a78, v62
    v_accvgpr_write_b32 a79, v63
    s_waitcnt vmcnt(13)
    ds_read_b128 v[64:67], v244 offset:4096
    ds_read_b128 v[68:71], v244 offset:6144
    ds_read_b128 v[72:75], v245 offset:4096
    ds_read_b128 v[76:79], v245 offset:6144
    buffer_load_dwordx4 v7, s[8:11], s30 offen offset:1024 nt lds
    s_waitcnt lgkmcnt(3)
    v_lshlrev_b32 v112, 16, v64
    v_and_b32 v113, 0xffff0000, v64
    v_lshlrev_b32 v114, 16, v65
    v_and_b32 v115, 0xffff0000, v65
    v_pk_mul_f32 v[112:113], v[112:113], s[78:79]
    v_pk_mul_f32 v[114:115], v[114:115], s[78:79]
    v_cvt_pk_bf16_f32 v64, v112, v113
    v_cvt_pk_bf16_f32 v65, v114, v115
    v_accvgpr_write_b32 a80, v64
    v_accvgpr_write_b32 a81, v65
    v_lshlrev_b32 v116, 16, v66
    v_and_b32 v117, 0xffff0000, v66
    v_lshlrev_b32 v118, 16, v67
    v_and_b32 v119, 0xffff0000, v67
    v_pk_mul_f32 v[116:117], v[116:117], s[78:79]
    v_pk_mul_f32 v[118:119], v[118:119], s[78:79]
    v_cvt_pk_bf16_f32 v66, v116, v117
    v_cvt_pk_bf16_f32 v67, v118, v119
    v_accvgpr_write_b32 a82, v66
    v_accvgpr_write_b32 a83, v67
    buffer_load_dwordx4 v8, s[8:11], s30 offen offset:2048 nt lds
    s_waitcnt lgkmcnt(2)
    v_lshlrev_b32 v120, 16, v68
    v_and_b32 v121, 0xffff0000, v68
    v_lshlrev_b32 v122, 16, v69
    v_and_b32 v123, 0xffff0000, v69
    v_pk_mul_f32 v[120:121], v[120:121], s[78:79]
    v_pk_mul_f32 v[122:123], v[122:123], s[78:79]
    v_cvt_pk_bf16_f32 v68, v120, v121
    v_cvt_pk_bf16_f32 v69, v122, v123
    v_accvgpr_write_b32 a84, v68
    v_accvgpr_write_b32 a85, v69
    v_lshlrev_b32 v124, 16, v70
    v_and_b32 v125, 0xffff0000, v70
    v_lshlrev_b32 v126, 16, v71
    v_and_b32 v127, 0xffff0000, v71
    v_pk_mul_f32 v[124:125], v[124:125], s[78:79]
    v_pk_mul_f32 v[126:127], v[126:127], s[78:79]
    v_cvt_pk_bf16_f32 v70, v124, v125
    v_cvt_pk_bf16_f32 v71, v126, v127
    v_accvgpr_write_b32 a86, v70
    v_accvgpr_write_b32 a87, v71
    buffer_load_dwordx4 v9, s[8:11], s30 offen offset:3072 nt lds
    s_waitcnt lgkmcnt(1)
    v_lshlrev_b32 v112, 16, v72
    v_and_b32 v113, 0xffff0000, v72
    v_lshlrev_b32 v114, 16, v73
    v_and_b32 v115, 0xffff0000, v73
    v_pk_mul_f32 v[112:113], v[112:113], s[78:79]
    v_pk_mul_f32 v[114:115], v[114:115], s[78:79]
    v_cvt_pk_bf16_f32 v72, v112, v113
    v_cvt_pk_bf16_f32 v73, v114, v115
    v_accvgpr_write_b32 a88, v72
    v_accvgpr_write_b32 a89, v73
    v_lshlrev_b32 v116, 16, v74
    v_and_b32 v117, 0xffff0000, v74
    v_lshlrev_b32 v118, 16, v75
    v_and_b32 v119, 0xffff0000, v75
    v_pk_mul_f32 v[116:117], v[116:117], s[78:79]
    v_pk_mul_f32 v[118:119], v[118:119], s[78:79]
    v_cvt_pk_bf16_f32 v74, v116, v117
    v_cvt_pk_bf16_f32 v75, v118, v119
    v_accvgpr_write_b32 a90, v74
    v_accvgpr_write_b32 a91, v75
    s_add_u32 s26, s26, 32768
    s_cmp_ge_u32 s26, 163840
    s_cselect_b32 s26, s34, s26
    s_waitcnt lgkmcnt(0)
    v_lshlrev_b32 v120, 16, v76
    v_and_b32 v121, 0xffff0000, v76
    v_lshlrev_b32 v122, 16, v77
    v_and_b32 v123, 0xffff0000, v77
    v_pk_mul_f32 v[120:121], v[120:121], s[78:79]
    v_pk_mul_f32 v[122:123], v[122:123], s[78:79]
    v_cvt_pk_bf16_f32 v76, v120, v121
    v_cvt_pk_bf16_f32 v77, v122, v123
    v_accvgpr_write_b32 a92, v76
    v_accvgpr_write_b32 a93, v77
    v_lshlrev_b32 v124, 16, v78
    v_and_b32 v125, 0xffff0000, v78
    v_lshlrev_b32 v126, 16, v79
    v_and_b32 v127, 0xffff0000, v79
    v_pk_mul_f32 v[124:125], v[124:125], s[78:79]
    v_pk_mul_f32 v[126:127], v[126:127], s[78:79]
    v_cvt_pk_bf16_f32 v78, v124, v125
    v_cvt_pk_bf16_f32 v79, v126, v127
    v_accvgpr_write_b32 a94, v78
    v_accvgpr_write_b32 a95, v79
    s_waitcnt vmcnt(12)
    ds_read_b128 v[80:83], v244 offset:8192
    ds_read_b128 v[84:87], v244 offset:10240
    ds_read_b128 v[88:91], v245 offset:8192
    ds_read_b128 v[92:95], v245 offset:10240
    buffer_store_dword v240, off, s[88:91], s94 sc1
    s_waitcnt lgkmcnt(3)
    v_lshlrev_b32 v112, 16, v80
    v_and_b32 v113, 0xffff0000, v80
    v_lshlrev_b32 v114, 16, v81
    v_and_b32 v115, 0xffff0000, v81
    v_pk_mul_f32 v[112:113], v[112:113], s[78:79]
    v_pk_mul_f32 v[114:115], v[114:115], s[78:79]
    v_cvt_pk_bf16_f32 v80, v112, v113
    v_cvt_pk_bf16_f32 v81, v114, v115
    v_accvgpr_write_b32 a96, v80
    v_accvgpr_write_b32 a97, v81
    v_lshlrev_b32 v116, 16, v82
    v_and_b32 v117, 0xffff0000, v82
    v_lshlrev_b32 v118, 16, v83
    v_and_b32 v119, 0xffff0000, v83
    v_pk_mul_f32 v[116:117], v[116:117], s[78:79]
    v_pk_mul_f32 v[118:119], v[118:119], s[78:79]
    s_mov_b32 m0, s26
    s_add_u32 s30, s23, 4096
    buffer_load_dwordx4 v2, s[8:11], s23 offen offset:0 nt lds
    v_cvt_pk_bf16_f32 v82, v116, v117
    v_cvt_pk_bf16_f32 v83, v118, v119
    v_accvgpr_write_b32 a98, v82
    v_accvgpr_write_b32 a99, v83
    s_waitcnt lgkmcnt(2)
    v_lshlrev_b32 v120, 16, v84
    v_and_b32 v121, 0xffff0000, v84
    v_lshlrev_b32 v122, 16, v85
    v_and_b32 v123, 0xffff0000, v85
    v_pk_mul_f32 v[120:121], v[120:121], s[78:79]
    v_pk_mul_f32 v[122:123], v[122:123], s[78:79]
    v_cvt_pk_bf16_f32 v84, v120, v121
    v_cvt_pk_bf16_f32 v85, v122, v123
    v_accvgpr_write_b32 a100, v84
    v_accvgpr_write_b32 a101, v85
    v_lshlrev_b32 v124, 16, v86
    v_and_b32 v125, 0xffff0000, v86
    buffer_load_dwordx4 v3, s[8:11], s23 offen offset:1024 nt lds
    v_lshlrev_b32 v126, 16, v87
    v_and_b32 v127, 0xffff0000, v87
    v_pk_mul_f32 v[124:125], v[124:125], s[78:79]
    v_pk_mul_f32 v[126:127], v[126:127], s[78:79]
    v_cvt_pk_bf16_f32 v86, v124, v125
    v_cvt_pk_bf16_f32 v87, v126, v127
    v_accvgpr_write_b32 a102, v86
    v_accvgpr_write_b32 a103, v87
    s_waitcnt lgkmcnt(1)
    v_lshlrev_b32 v112, 16, v88
    v_and_b32 v113, 0xffff0000, v88
    v_lshlrev_b32 v114, 16, v89
    v_and_b32 v115, 0xffff0000, v89
    v_pk_mul_f32 v[112:113], v[112:113], s[78:79]
    v_pk_mul_f32 v[114:115], v[114:115], s[78:79]
    v_cvt_pk_bf16_f32 v88, v112, v113
    v_cvt_pk_bf16_f32 v89, v114, v115
    buffer_load_dwordx4 v4, s[8:11], s23 offen offset:2048 nt lds
    v_accvgpr_write_b32 a104, v88
    v_accvgpr_write_b32 a105, v89
    v_lshlrev_b32 v116, 16, v90
    v_and_b32 v117, 0xffff0000, v90
    v_lshlrev_b32 v118, 16, v91
    v_and_b32 v119, 0xffff0000, v91
    v_pk_mul_f32 v[116:117], v[116:117], s[78:79]
    v_pk_mul_f32 v[118:119], v[118:119], s[78:79]
    v_cvt_pk_bf16_f32 v90, v116, v117
    v_cvt_pk_bf16_f32 v91, v118, v119
    v_accvgpr_write_b32 a106, v90
    v_accvgpr_write_b32 a107, v91
    s_waitcnt lgkmcnt(0)
    v_lshlrev_b32 v120, 16, v92
    v_and_b32 v121, 0xffff0000, v92
    v_lshlrev_b32 v122, 16, v93
    v_and_b32 v123, 0xffff0000, v93
    buffer_load_dwordx4 v5, s[8:11], s23 offen offset:3072 nt lds
    v_pk_mul_f32 v[120:121], v[120:121], s[78:79]
    v_pk_mul_f32 v[122:123], v[122:123], s[78:79]
    v_cvt_pk_bf16_f32 v92, v120, v121
    v_cvt_pk_bf16_f32 v93, v122, v123
    v_accvgpr_write_b32 a108, v92
    v_accvgpr_write_b32 a109, v93
    v_lshlrev_b32 v124, 16, v94
    v_and_b32 v125, 0xffff0000, v94
    v_lshlrev_b32 v126, 16, v95
    v_and_b32 v127, 0xffff0000, v95
    v_pk_mul_f32 v[124:125], v[124:125], s[78:79]
    v_pk_mul_f32 v[126:127], v[126:127], s[78:79]
    v_cvt_pk_bf16_f32 v94, v124, v125
    v_cvt_pk_bf16_f32 v95, v126, v127
    v_accvgpr_write_b32 a110, v94
    v_accvgpr_write_b32 a111, v95
    s_waitcnt vmcnt(13)
    ds_read_b128 v[96:99], v244 offset:12288
    ds_read_b128 v[100:103], v244 offset:14336
    ds_read_b128 v[104:107], v245 offset:12288
    ds_read_b128 v[108:111], v245 offset:14336
    s_add_u32 m0, s26, 4096
    s_add_u32 s23, s23, 32768
    buffer_load_dwordx4 v6, s[8:11], s30 offen offset:0 nt lds
    s_waitcnt lgkmcnt(3)
    v_lshlrev_b32 v112, 16, v96
    v_and_b32 v113, 0xffff0000, v96
    v_lshlrev_b32 v114, 16, v97
    v_and_b32 v115, 0xffff0000, v97
    v_pk_mul_f32 v[112:113], v[112:113], s[78:79]
    v_pk_mul_f32 v[114:115], v[114:115], s[78:79]
    v_cvt_pk_bf16_f32 v96, v112, v113
    v_cvt_pk_bf16_f32 v97, v114, v115
    v_accvgpr_write_b32 a112, v96
    v_accvgpr_write_b32 a113, v97
    v_lshlrev_b32 v116, 16, v98
    v_and_b32 v117, 0xffff0000, v98
    v_lshlrev_b32 v118, 16, v99
    v_and_b32 v119, 0xffff0000, v99
    v_pk_mul_f32 v[116:117], v[116:117], s[78:79]
    v_pk_mul_f32 v[118:119], v[118:119], s[78:79]
    buffer_load_dwordx4 v7, s[8:11], s30 offen offset:1024 nt lds
    v_cvt_pk_bf16_f32 v98, v116, v117
    v_cvt_pk_bf16_f32 v99, v118, v119
    v_accvgpr_write_b32 a114, v98
    v_accvgpr_write_b32 a115, v99
    s_waitcnt lgkmcnt(2)
    v_lshlrev_b32 v120, 16, v100
    v_and_b32 v121, 0xffff0000, v100
    v_lshlrev_b32 v122, 16, v101
    v_and_b32 v123, 0xffff0000, v101
    v_pk_mul_f32 v[120:121], v[120:121], s[78:79]
    v_pk_mul_f32 v[122:123], v[122:123], s[78:79]
    v_cvt_pk_bf16_f32 v100, v120, v121
    v_cvt_pk_bf16_f32 v101, v122, v123
    v_accvgpr_write_b32 a116, v100
    v_accvgpr_write_b32 a117, v101
    v_lshlrev_b32 v124, 16, v102
    v_and_b32 v125, 0xffff0000, v102
    buffer_load_dwordx4 v8, s[8:11], s30 offen offset:2048 nt lds
    v_lshlrev_b32 v126, 16, v103
    v_and_b32 v127, 0xffff0000, v103
    v_pk_mul_f32 v[124:125], v[124:125], s[78:79]
    v_pk_mul_f32 v[126:127], v[126:127], s[78:79]
    v_cvt_pk_bf16_f32 v102, v124, v125
    v_cvt_pk_bf16_f32 v103, v126, v127
    v_accvgpr_write_b32 a118, v102
    v_accvgpr_write_b32 a119, v103
    s_waitcnt lgkmcnt(1)
    v_lshlrev_b32 v112, 16, v104
    v_and_b32 v113, 0xffff0000, v104
    v_lshlrev_b32 v114, 16, v105
    v_and_b32 v115, 0xffff0000, v105
    v_pk_mul_f32 v[112:113], v[112:113], s[78:79]
    v_pk_mul_f32 v[114:115], v[114:115], s[78:79]
    v_cvt_pk_bf16_f32 v104, v112, v113
    v_cvt_pk_bf16_f32 v105, v114, v115
    buffer_load_dwordx4 v9, s[8:11], s30 offen offset:3072 nt lds
    v_accvgpr_write_b32 a120, v104
    v_accvgpr_write_b32 a121, v105
    v_lshlrev_b32 v116, 16, v106
    v_and_b32 v117, 0xffff0000, v106
    v_lshlrev_b32 v118, 16, v107
    v_and_b32 v119, 0xffff0000, v107
    v_pk_mul_f32 v[116:117], v[116:117], s[78:79]
    v_pk_mul_f32 v[118:119], v[118:119], s[78:79]
    v_cvt_pk_bf16_f32 v106, v116, v117
    v_cvt_pk_bf16_f32 v107, v118, v119
    v_accvgpr_write_b32 a122, v106
    v_accvgpr_write_b32 a123, v107
    s_waitcnt lgkmcnt(0)
    v_lshlrev_b32 v120, 16, v108
    v_and_b32 v121, 0xffff0000, v108
    v_lshlrev_b32 v122, 16, v109
    v_and_b32 v123, 0xffff0000, v109
    s_add_u32 s26, s26, 32768
    s_cmp_ge_u32 s26, 163840
    s_cselect_b32 s26, s34, s26
    v_pk_mul_f32 v[120:121], v[120:121], s[78:79]
    v_pk_mul_f32 v[122:123], v[122:123], s[78:79]
    v_cvt_pk_bf16_f32 v108, v120, v121
    v_cvt_pk_bf16_f32 v109, v122, v123
    v_accvgpr_write_b32 a124, v108
    v_accvgpr_write_b32 a125, v109
    v_lshlrev_b32 v124, 16, v110
    v_and_b32 v125, 0xffff0000, v110
    v_lshlrev_b32 v126, 16, v111
    v_and_b32 v127, 0xffff0000, v111
    v_pk_mul_f32 v[124:125], v[124:125], s[78:79]
    v_pk_mul_f32 v[126:127], v[126:127], s[78:79]
    v_cvt_pk_bf16_f32 v110, v124, v125
    v_cvt_pk_bf16_f32 v111, v126, v127
    v_accvgpr_write_b32 a126, v110
    v_accvgpr_write_b32 a127, v111
    s_waitcnt vmcnt(9)
    v_mov_b32 v18, v14
    v_mov_b32 v19, v15
    v_mov_b32 v20, v16
    v_mov_b32 v21, v17
    s_barrier
    ds_read_b128 a[128:131], v18 offset:0
    ds_read_b128 a[132:135], v18 offset:8192
    ds_read_b128 a[136:139], v18 offset:16384
    ds_read_b128 a[140:143], v18 offset:24576
    ds_read_b128 a[144:147], v19 offset:0
    ds_read_b128 a[148:151], v19 offset:8192
    s_waitcnt lgkmcnt(4)
    v_mfma_f32_16x16x32_bf16 v[48:51], a[128:131], a[64:67], 0
    s_mov_b32 m0, s26
    ds_read_b128 a[152:155], v19 offset:16384
    v_mfma_f32_16x16x32_bf16 v[52:55], a[128:131], a[68:71], 0
    s_add_u32 s30, s24, 4096
    v_mfma_f32_16x16x32_bf16 v[56:59], a[132:135], a[64:67], 0
    ds_read_b128 a[156:159], v19 offset:24576
    v_mfma_f32_16x16x32_bf16 v[60:63], a[132:135], a[68:71], 0
    s_waitcnt lgkmcnt(4)
    buffer_load_dwordx4 v10, s[12:15], s24 offen offset:0 nt lds
    v_mfma_f32_16x16x32_bf16 v[64:67], a[136:139], a[64:67], 0
    ds_read_b128 a[160:163], v20 offset:0
    buffer_load_dwordx4 v11, s[12:15], s24 offen offset:1024 nt lds
    v_mfma_f32_16x16x32_bf16 v[68:71], a[136:139], a[68:71], 0
    buffer_load_dwordx4 v12, s[12:15], s24 offen offset:2048 nt lds
    v_mfma_f32_16x16x32_bf16 v[72:75], a[140:143], a[64:67], 0
    ds_read_b128 a[164:167], v20 offset:8192
    buffer_load_dwordx4 v13, s[12:15], s24 offen offset:3072 nt lds
    v_mfma_f32_16x16x32_bf16 v[76:79], a[140:143], a[68:71], 0
    s_waitcnt lgkmcnt(4)
    v_mfma_f32_16x16x32_bf16 v[48:51], a[144:147], a[72:75], v[48:51]
    s_add_u32 m0, s26, 4096
    ds_read_b128 a[168:171], v20 offset:16384
    v_mfma_f32_16x16x32_bf16 v[52:55], a[144:147], a[76:79], v[52:55]
    s_add_u32 s24, s24, 32768
    v_mfma_f32_16x16x32_bf16 v[56:59], a[148:151], a[72:75], v[56:59]
    ds_read_b128 a[172:175], v20 offset:24576
    buffer_load_dwordx4 v10, s[12:15], s30 offen offset:0 nt lds
    v_mfma_f32_16x16x32_bf16 v[60:63], a[148:151], a[76:79], v[60:63]
    s_waitcnt lgkmcnt(4)
    buffer_load_dwordx4 v11, s[12:15], s30 offen offset:1024 nt lds
    v_mfma_f32_16x16x32_bf16 v[64:67], a[152:155], a[72:75], v[64:67]
    ds_read_b128 a[176:179], v21 offset:0
    buffer_load_dwordx4 v12, s[12:15], s30 offen offset:2048 nt lds
    v_mfma_f32_16x16x32_bf16 v[68:71], a[152:155], a[76:79], v[68:71]
    buffer_load_dwordx4 v13, s[12:15], s30 offen offset:3072 nt lds
    v_mfma_f32_16x16x32_bf16 v[72:75], a[156:159], a[72:75], v[72:75]
    s_add_u32 s26, s26, 32768
    ds_read_b128 a[180:183], v21 offset:8192
    v_mfma_f32_16x16x32_bf16 v[76:79], a[156:159], a[76:79], v[76:79]
    s_waitcnt lgkmcnt(4)
    v_mfma_f32_16x16x32_bf16 v[48:51], a[160:163], a[80:83], v[48:51]
    s_cmp_ge_u32 s26, 163840
    ds_read_b128 a[184:187], v21 offset:16384
    v_mfma_f32_16x16x32_bf16 v[52:55], a[160:163], a[84:87], v[52:55]
    s_cselect_b32 s26, s34, s26
    v_mfma_f32_16x16x32_bf16 v[56:59], a[164:167], a[80:83], v[56:59]
    ds_read_b128 a[188:191], v21 offset:24576
    v_mfma_f32_16x16x32_bf16 v[60:63], a[164:167], a[84:87], v[60:63]
    s_waitcnt lgkmcnt(4)
    v_mfma_f32_16x16x32_bf16 v[64:67], a[168:171], a[80:83], v[64:67]
    ds_read_b128 a[128:131], v18 offset:256
    v_mfma_f32_16x16x32_bf16 v[68:71], a[168:171], a[84:87], v[68:71]
    v_mfma_f32_16x16x32_bf16 v[72:75], a[172:175], a[80:83], v[72:75]
    ds_read_b128 a[132:135], v18 offset:8448
    v_mfma_f32_16x16x32_bf16 v[76:79], a[172:175], a[84:87], v[76:79]
    s_waitcnt lgkmcnt(4)
    v_mfma_f32_16x16x32_bf16 v[48:51], a[176:179], a[88:91], v[48:51]
    ds_read_b128 a[136:139], v18 offset:16640
    v_mfma_f32_16x16x32_bf16 v[52:55], a[176:179], a[92:95], v[52:55]
    v_mfma_f32_16x16x32_bf16 v[56:59], a[180:183], a[88:91], v[56:59]
    ds_read_b128 a[140:143], v18 offset:24832
    v_mfma_f32_16x16x32_bf16 v[60:63], a[180:183], a[92:95], v[60:63]
    s_waitcnt lgkmcnt(4)
    v_add_u32 v18, 32768, v14
    v_mfma_f32_16x16x32_bf16 v[64:67], a[184:187], a[88:91], v[64:67]
    ds_read_b128 a[144:147], v19 offset:256
    v_mfma_f32_16x16x32_bf16 v[68:71], a[184:187], a[92:95], v[68:71]
    v_mfma_f32_16x16x32_bf16 v[72:75], a[188:191], a[88:91], v[72:75]
    ds_read_b128 a[148:151], v19 offset:8448
    v_mfma_f32_16x16x32_bf16 v[76:79], a[188:191], a[92:95], v[76:79]
    s_waitcnt lgkmcnt(4)
    v_mfma_f32_16x16x32_bf16 v[48:51], a[128:131], a[96:99], v[48:51]
    ds_read_b128 a[152:155], v19 offset:16640
    v_mfma_f32_16x16x32_bf16 v[52:55], a[128:131], a[100:103], v[52:55]
    v_mfma_f32_16x16x32_bf16 v[56:59], a[132:135], a[96:99], v[56:59]
    ds_read_b128 a[156:159], v19 offset:24832
    v_mfma_f32_16x16x32_bf16 v[60:63], a[132:135], a[100:103], v[60:63]
    s_waitcnt lgkmcnt(4)
    v_add_u32 v19, 32768, v15
    v_mfma_f32_16x16x32_bf16 v[64:67], a[136:139], a[96:99], v[64:67]
    ds_read_b128 a[160:163], v20 offset:256
    v_mfma_f32_16x16x32_bf16 v[68:71], a[136:139], a[100:103], v[68:71]
    v_mfma_f32_16x16x32_bf16 v[72:75], a[140:143], a[96:99], v[72:75]
    ds_read_b128 a[164:167], v20 offset:8448
    v_mfma_f32_16x16x32_bf16 v[76:79], a[140:143], a[100:103], v[76:79]
    s_waitcnt lgkmcnt(4)
    v_mfma_f32_16x16x32_bf16 v[48:51], a[144:147], a[104:107], v[48:51]
    ds_read_b128 a[168:171], v20 offset:16640
    v_mfma_f32_16x16x32_bf16 v[52:55], a[144:147], a[108:111], v[52:55]
    v_mfma_f32_16x16x32_bf16 v[56:59], a[148:151], a[104:107], v[56:59]
    ds_read_b128 a[172:175], v20 offset:24832
    v_mfma_f32_16x16x32_bf16 v[60:63], a[148:151], a[108:111], v[60:63]
    s_waitcnt lgkmcnt(4)
    v_add_u32 v20, 32768, v16
    v_mfma_f32_16x16x32_bf16 v[64:67], a[152:155], a[104:107], v[64:67]
    ds_read_b128 a[176:179], v21 offset:256
    v_mfma_f32_16x16x32_bf16 v[68:71], a[152:155], a[108:111], v[68:71]
    v_mfma_f32_16x16x32_bf16 v[72:75], a[156:159], a[104:107], v[72:75]
    ds_read_b128 a[180:183], v21 offset:8448
    v_mfma_f32_16x16x32_bf16 v[76:79], a[156:159], a[108:111], v[76:79]
    s_waitcnt lgkmcnt(4)
    v_mfma_f32_16x16x32_bf16 v[48:51], a[160:163], a[112:115], v[48:51]
    ds_read_b128 a[184:187], v21 offset:16640
    v_mfma_f32_16x16x32_bf16 v[52:55], a[160:163], a[116:119], v[52:55]
    v_mfma_f32_16x16x32_bf16 v[56:59], a[164:167], a[112:115], v[56:59]
    ds_read_b128 a[188:191], v21 offset:24832
    v_mfma_f32_16x16x32_bf16 v[60:63], a[164:167], a[116:119], v[60:63]
    s_waitcnt lgkmcnt(4)
    v_add_u32 v21, 32768, v17
    v_mfma_f32_16x16x32_bf16 v[64:67], a[168:171], a[112:115], v[64:67]
    s_waitcnt vmcnt(8)
    s_barrier
    ds_read_b128 a[128:131], v18 offset:0
    v_mfma_f32_16x16x32_bf16 v[68:71], a[168:171], a[116:119], v[68:71]
    v_mfma_f32_16x16x32_bf16 v[72:75], a[172:175], a[112:115], v[72:75]
    ds_read_b128 a[132:135], v18 offset:8192
    v_mfma_f32_16x16x32_bf16 v[76:79], a[172:175], a[116:119], v[76:79]
    s_waitcnt lgkmcnt(4)
    v_mfma_f32_16x16x32_bf16 v[48:51], a[176:179], a[120:123], v[48:51]
    ds_read_b128 a[136:139], v18 offset:16384
    v_mfma_f32_16x16x32_bf16 v[52:55], a[176:179], a[124:127], v[52:55]
    v_mfma_f32_16x16x32_bf16 v[56:59], a[180:183], a[120:123], v[56:59]
    ds_read_b128 a[140:143], v18 offset:24576
    v_mfma_f32_16x16x32_bf16 v[60:63], a[180:183], a[124:127], v[60:63]
    s_waitcnt lgkmcnt(4)
    v_mfma_f32_16x16x32_bf16 v[64:67], a[184:187], a[120:123], v[64:67]
    ds_read_b128 a[144:147], v19 offset:0
    v_mfma_f32_16x16x32_bf16 v[68:71], a[184:187], a[124:127], v[68:71]
    v_mfma_f32_16x16x32_bf16 v[72:75], a[188:191], a[120:123], v[72:75]
    ds_read_b128 a[148:151], v19 offset:8192
    v_mfma_f32_16x16x32_bf16 v[76:79], a[188:191], a[124:127], v[76:79]
    s_nop 5
    v_max3_f32 v42, v48, v49, v50
    v_max3_f32 v43, v52, v53, v54
    v_max3_f32 v42, v51, v56, v42
    v_max3_f32 v43, v55, v60, v43
    v_max3_f32 v42, v57, v58, v42
    v_max3_f32 v43, v61, v62, v43
    v_max3_f32 v42, v59, v64, v42
    v_max3_f32 v43, v63, v68, v43
    v_max3_f32 v42, v65, v66, v42
    v_max3_f32 v43, v69, v70, v43
    v_max3_f32 v42, v67, v72, v42
    v_max3_f32 v43, v71, v76, v43
    v_max3_f32 v42, v73, v74, v42
    v_max3_f32 v43, v77, v78, v43
    v_max_f32 v42, v75, v42
    v_max_f32 v43, v79, v43
    v_mov_b32 v44, v42
    v_mov_b32 v45, v43
    s_nop 1
    v_permlane32_swap_b32 v42, v44
    v_permlane32_swap_b32 v43, v45
    s_nop 1
    v_max_f32 v42, v42, v44
    v_max_f32 v43, v43, v45
    v_mov_b32 v44, v42
    v_mov_b32 v45, v43
    s_nop 1
    v_permlane16_swap_b32 v42, v44
    v_permlane16_swap_b32 v43, v45
    s_nop 1
    v_max_f32 v42, v42, v44
    v_max_f32 v43, v43, v45
    v_ceil_f32 v38, v42
    v_ceil_f32 v39, v43
    v_sub_f32 v244, 0, v38
    v_sub_f32 v245, 0, v38
    v_sub_f32 v246, 0, v38
    v_sub_f32 v247, 0, v38
    v_sub_f32 v248, 0, v39
    v_sub_f32 v249, 0, v39
    v_sub_f32 v250, 0, v39
    v_sub_f32 v251, 0, v39
    s_nop 0
    s_waitcnt lgkmcnt(4)
    v_mfma_f32_16x16x32_bf16 v[80:83], a[128:131], a[64:67], v[244:247]
    s_mov_b32 m0, s26
    ds_read_b128 a[152:155], v19 offset:16384
    v_sub_f32 v48, v48, v38
    v_mfma_f32_16x16x32_bf16 v[84:87], a[128:131], a[68:71], v[248:251]
    s_add_u32 s30, s23, 4096
    v_exp_f32 v48, v48
    v_sub_f32 v49, v49, v38
    v_mfma_f32_16x16x32_bf16 v[88:91], a[132:135], a[64:67], v[244:247]
    ds_read_b128 a[156:159], v19 offset:24576
    v_sub_f32 v50, v50, v38
    v_sub_f32 v51, v51, v38
    v_mfma_f32_16x16x32_bf16 v[92:95], a[132:135], a[68:71], v[248:251]
    s_waitcnt lgkmcnt(4)
    buffer_load_dwordx4 v2, s[8:11], s23 offen offset:0 nt lds
    v_sub_f32 v52, v52, v39
    v_mfma_f32_16x16x32_bf16 v[96:99], a[136:139], a[64:67], v[244:247]
    ds_read_b128 a[160:163], v20 offset:0
    v_sub_f32 v53, v53, v39
    v_sub_f32 v54, v54, v39
    v_mfma_f32_16x16x32_bf16 v[100:103], a[136:139], a[68:71], v[248:251]
    buffer_load_dwordx4 v3, s[8:11], s23 offen offset:1024 nt lds
    v_mfma_f32_16x16x32_bf16 v[104:107], a[140:143], a[64:67], v[244:247]
    ds_read_b128 a[164:167], v20 offset:8192
    v_exp_f32 v49, v49
    v_mfma_f32_16x16x32_bf16 v[108:111], a[140:143], a[68:71], v[248:251]
    s_waitcnt lgkmcnt(4)
    v_exp_f32 v50, v50
    v_exp_f32 v51, v51
    v_mfma_f32_16x16x32_bf16 v[80:83], a[144:147], a[72:75], v[80:83]
    ds_read_b128 a[168:171], v20 offset:16384
    v_cvt_pk_bf16_f32 v112, v48, v49
    v_mfma_f32_16x16x32_bf16 v[84:87], a[144:147], a[76:79], v[84:87]
    buffer_load_dwordx4 v4, s[8:11], s23 offen offset:2048 nt lds
    v_cvt_pk_bf16_f32 v113, v50, v51
    v_mfma_f32_16x16x32_bf16 v[88:91], a[148:151], a[72:75], v[88:91]
    ds_read_b128 a[172:175], v20 offset:24576
    v_sub_f32 v55, v55, v39
    v_sub_f32 v56, v56, v38
    v_mfma_f32_16x16x32_bf16 v[92:95], a[148:151], a[76:79], v[92:95]
    s_waitcnt lgkmcnt(4)
    buffer_load_dwordx4 v5, s[8:11], s23 offen offset:3072 nt lds
    v_sub_f32 v57, v57, v38
    v_mfma_f32_16x16x32_bf16 v[96:99], a[152:155], a[72:75], v[96:99]
    s_add_u32 m0, s26, 4096
    ds_read_b128 a[176:179], v21 offset:0
    v_exp_f32 v52, v52
    v_mfma_f32_16x16x32_bf16 v[100:103], a[152:155], a[76:79], v[100:103]
    s_add_u32 s23, s23, 32768
    v_exp_f32 v53, v53
    v_sub_f32 v58, v58, v38
    v_mfma_f32_16x16x32_bf16 v[104:107], a[156:159], a[72:75], v[104:107]
    ds_read_b128 a[180:183], v21 offset:8192
    v_cvt_pk_bf16_f32 v116, v52, v53
    v_sub_f32 v59, v59, v38
    v_mfma_f32_16x16x32_bf16 v[108:111], a[156:159], a[76:79], v[108:111]
    s_waitcnt lgkmcnt(4)
    buffer_load_dwordx4 v6, s[8:11], s30 offen offset:0 nt lds
    v_mfma_f32_16x16x32_bf16 v[80:83], a[160:163], a[80:83], v[80:83]
    ds_read_b128 a[184:187], v21 offset:16384
    v_exp_f32 v54, v54
    v_mfma_f32_16x16x32_bf16 v[84:87], a[160:163], a[84:87], v[84:87]
    buffer_load_dwordx4 v7, s[8:11], s30 offen offset:1024 nt lds
    v_sub_f32 v60, v60, v39
    v_mfma_f32_16x16x32_bf16 v[88:91], a[164:167], a[80:83], v[88:91]
    ds_read_b128 a[188:191], v21 offset:24576
    v_exp_f32 v55, v55
    v_mfma_f32_16x16x32_bf16 v[92:95], a[164:167], a[84:87], v[92:95]
    s_waitcnt lgkmcnt(4)
    v_exp_f32 v56, v56
    v_cvt_pk_bf16_f32 v117, v54, v55
    v_mfma_f32_16x16x32_bf16 v[96:99], a[168:171], a[80:83], v[96:99]
    ds_read_b128 a[128:131], v18 offset:256
    v_sub_f32 v61, v61, v39
    v_sub_f32 v62, v62, v39
    v_mfma_f32_16x16x32_bf16 v[100:103], a[168:171], a[84:87], v[100:103]
    buffer_load_dwordx4 v8, s[8:11], s30 offen offset:2048 nt lds
    v_mfma_f32_16x16x32_bf16 v[104:107], a[172:175], a[80:83], v[104:107]
    ds_read_b128 a[132:135], v18 offset:8448
    v_exp_f32 v57, v57
    v_mfma_f32_16x16x32_bf16 v[108:111], a[172:175], a[84:87], v[108:111]
    s_waitcnt lgkmcnt(4)
    buffer_load_dwordx4 v9, s[8:11], s30 offen offset:3072 nt lds
    v_exp_f32 v58, v58
    v_mfma_f32_16x16x32_bf16 v[80:83], a[176:179], a[88:91], v[80:83]
    s_add_u32 s26, s26, 32768
    ds_read_b128 a[136:139], v18 offset:16640
    v_cvt_pk_bf16_f32 v114, v56, v57
    v_mfma_f32_16x16x32_bf16 v[84:87], a[176:179], a[92:95], v[84:87]
    s_cmp_ge_u32 s26, 163840
    v_exp_f32 v59, v59
    v_sub_f32 v63, v63, v39
    v_mfma_f32_16x16x32_bf16 v[88:91], a[180:183], a[88:91], v[88:91]
    s_cselect_b32 s26, s34, s26
    ds_read_b128 a[140:143], v18 offset:24832
    v_cvt_pk_bf16_f32 v115, v58, v59
    v_sub_f32 v64, v64, v38
    v_mfma_f32_16x16x32_bf16 v[92:95], a[180:183], a[92:95], v[92:95]
    s_waitcnt lgkmcnt(4)
    v_exp_f32 v60, v60
    v_sub_f32 v65, v65, v38
    v_mfma_f32_16x16x32_bf16 v[96:99], a[184:187], a[88:91], v[96:99]
    s_mov_b32 m0, s26
    ds_read_b128 a[144:147], v19 offset:256
    v_sub_f32 v66, v66, v38
    v_mfma_f32_16x16x32_bf16 v[100:103], a[184:187], a[92:95], v[100:103]
    s_add_u32 s30, s24, 4096
    v_exp_f32 v61, v61
    v_exp_f32 v62, v62
    v_mfma_f32_16x16x32_bf16 v[104:107], a[188:191], a[88:91], v[104:107]
    ds_read_b128 a[148:151], v19 offset:8448
    v_cvt_pk_bf16_f32 v118, v60, v61
    buffer_load_dwordx4 v10, s[12:15], s24 offen offset:0 nt lds
    v_mfma_f32_16x16x32_bf16 v[108:111], a[188:191], a[92:95], v[108:111]
    s_waitcnt lgkmcnt(4)
    buffer_load_dwordx4 v11, s[12:15], s24 offen offset:1024 nt lds
    v_mfma_f32_16x16x32_bf16 v[80:83], a[128:131], a[96:99], v[80:83]
    ds_read_b128 a[152:155], v19 offset:16640
    v_sub_f32 v67, v67, v38
    v_mfma_f32_16x16x32_bf16 v[84:87], a[128:131], a[100:103], v[84:87]
    buffer_load_dwordx4 v12, s[12:15], s24 offen offset:2048 nt lds
    v_sub_f32 v68, v68, v39
    v_mfma_f32_16x16x32_bf16 v[88:91], a[132:135], a[96:99], v[88:91]
    ds_read_b128 a[156:159], v19 offset:24832
    v_exp_f32 v63, v63
    v_mfma_f32_16x16x32_bf16 v[92:95], a[132:135], a[100:103], v[92:95]
    s_waitcnt lgkmcnt(4)
    buffer_load_dwordx4 v13, s[12:15], s24 offen offset:3072 nt lds
    v_cvt_pk_bf16_f32 v119, v62, v63
    v_mfma_f32_16x16x32_bf16 v[96:99], a[136:139], a[96:99], v[96:99]
    s_add_u32 m0, s26, 4096
    ds_read_b128 a[160:163], v20 offset:256
    v_sub_f32 v69, v69, v39
    v_mfma_f32_16x16x32_bf16 v[100:103], a[136:139], a[100:103], v[100:103]
    s_add_u32 s24, s24, 32768
    v_exp_f32 v64, v64
    v_exp_f32 v65, v65
    v_mfma_f32_16x16x32_bf16 v[104:107], a[140:143], a[96:99], v[104:107]
    ds_read_b128 a[164:167], v20 offset:8448
    v_cvt_pk_bf16_f32 v120, v64, v65
    v_sub_f32 v70, v70, v39
    v_mfma_f32_16x16x32_bf16 v[108:111], a[140:143], a[100:103], v[108:111]
    s_waitcnt lgkmcnt(4)
    buffer_load_dwordx4 v10, s[12:15], s30 offen offset:0 nt lds
    v_sub_f32 v71, v71, v39
    v_mfma_f32_16x16x32_bf16 v[80:83], a[144:147], a[104:107], v[80:83]
    ds_read_b128 a[168:171], v20 offset:16640
    v_mfma_f32_16x16x32_bf16 v[84:87], a[144:147], a[108:111], v[84:87]
    buffer_load_dwordx4 v11, s[12:15], s30 offen offset:1024 nt lds
    v_mfma_f32_16x16x32_bf16 v[88:91], a[148:151], a[104:107], v[88:91]
    ds_read_b128 a[172:175], v20 offset:24832
    v_exp_f32 v66, v66
    v_mfma_f32_16x16x32_bf16 v[92:95], a[148:151], a[108:111], v[92:95]
    s_waitcnt lgkmcnt(4)
    v_exp_f32 v67, v67
    v_exp_f32 v68, v68
    v_mfma_f32_16x16x32_bf16 v[96:99], a[152:155], a[104:107], v[96:99]
    ds_read_b128 a[176:179], v21 offset:256
    v_cvt_pk_bf16_f32 v121, v66, v67
    v_sub_f32 v72, v72, v38
    v_mfma_f32_16x16x32_bf16 v[100:103], a[152:155], a[108:111], v[100:103]
    buffer_load_dwordx4 v12, s[12:15], s30 offen offset:2048 nt lds
    v_sub_f32 v73, v73, v38
    v_mfma_f32_16x16x32_bf16 v[104:107], a[156:159], a[104:107], v[104:107]
    ds_read_b128 a[180:183], v21 offset:8448
    v_sub_f32 v74, v74, v38
    v_mfma_f32_16x16x32_bf16 v[108:111], a[156:159], a[108:111], v[108:111]
    s_waitcnt lgkmcnt(4)
    buffer_load_dwordx4 v13, s[12:15], s30 offen offset:3072 nt lds
    v_exp_f32 v69, v69
    v_mfma_f32_16x16x32_bf16 v[80:83], a[160:163], a[112:115], v[80:83]
    s_add_u32 s26, s26, 32768
    ds_read_b128 a[184:187], v21 offset:16640
    v_cvt_pk_bf16_f32 v124, v68, v69
    v_mfma_f32_16x16x32_bf16 v[84:87], a[160:163], a[116:119], v[84:87]
    s_cmp_ge_u32 s26, 163840
    v_exp_f32 v70, v70
    v_sub_f32 v75, v75, v38
    v_mfma_f32_16x16x32_bf16 v[88:91], a[164:167], a[112:115], v[88:91]
    s_cselect_b32 s26, s34, s26
    ds_read_b128 a[188:191], v21 offset:24832
    v_sub_f32 v76, v76, v39
    v_mfma_f32_16x16x32_bf16 v[92:95], a[164:167], a[116:119], v[92:95]
    s_waitcnt lgkmcnt(4)
    v_exp_f32 v71, v71
    v_exp_f32 v72, v72
    v_mfma_f32_16x16x32_bf16 v[96:99], a[168:171], a[112:115], v[96:99]
    s_waitcnt vmcnt(16)
    s_barrier
    ds_read_b64_tr_b16 a[128:129], v30 offset:256
    ds_read_b64_tr_b16 a[130:131], v30 offset:8448
    v_cvt_pk_bf16_f32 v125, v70, v71
    v_mfma_f32_16x16x32_bf16 v[100:103], a[168:171], a[116:119], v[100:103]
    v_exp_f32 v73, v73
    v_sub_f32 v77, v77, v39
    v_mfma_f32_16x16x32_bf16 v[104:107], a[172:175], a[112:115], v[104:107]
    ds_read_b64_tr_b16 a[132:133], v31 offset:256
    ds_read_b64_tr_b16 a[134:135], v31 offset:8448
    v_cvt_pk_bf16_f32 v122, v72, v73
    v_mfma_f32_16x16x32_bf16 v[108:111], a[172:175], a[116:119], v[108:111]
    s_waitcnt lgkmcnt(6)
    v_exp_f32 v74, v74
    v_sub_f32 v78, v78, v39
    v_mfma_f32_16x16x32_bf16 v[80:83], a[176:179], a[120:123], v[80:83]
    ds_read_b64_tr_b16 a[136:137], v32 offset:256
    ds_read_b64_tr_b16 a[138:139], v32 offset:8448
    v_mfma_f32_16x16x32_bf16 v[84:87], a[176:179], a[124:127], v[84:87]
    v_exp_f32 v75, v75
    v_sub_f32 v79, v79, v39
    v_mfma_f32_16x16x32_bf16 v[88:91], a[180:183], a[120:123], v[88:91]
    ds_read_b64_tr_b16 a[140:141], v33 offset:256
    ds_read_b64_tr_b16 a[142:143], v33 offset:8448
    v_cvt_pk_bf16_f32 v123, v74, v75
    v_mfma_f32_16x16x32_bf16 v[92:95], a[180:183], a[124:127], v[92:95]
    s_waitcnt lgkmcnt(8)
    v_exp_f32 v76, v76
    v_mfma_f32_16x16x32_bf16 v[96:99], a[184:187], a[120:123], v[96:99]
    ds_read_b64_tr_b16 a[144:145], v34 offset:256
    ds_read_b64_tr_b16 a[146:147], v34 offset:8448
    v_exp_f32 v77, v77
    v_mfma_f32_16x16x32_bf16 v[100:103], a[184:187], a[124:127], v[100:103]
    v_exp_f32 v78, v78
    v_cvt_pk_bf16_f32 v126, v76, v77
    v_mfma_f32_16x16x32_bf16 v[104:107], a[188:191], a[120:123], v[104:107]
    ds_read_b64_tr_b16 a[148:149], v35 offset:256
    ds_read_b64_tr_b16 a[150:151], v35 offset:8448
    v_mfma_f32_16x16x32_bf16 v[108:111], a[188:191], a[124:127], v[108:111]
    v_exp_f32 v79, v79
    s_nop 0
    v_cvt_pk_bf16_f32 v127, v78, v79
    s_waitcnt lgkmcnt(8)
    v_mfma_f32_16x16x32_bf16 v[128:131], a[128:131], v[112:115], v[128:131]
    s_mov_b32 m0, s26
    ds_read_b64_tr_b16 a[152:153], v36 offset:256
    ds_read_b64_tr_b16 a[154:155], v36 offset:8448
    v_mfma_f32_16x16x32_bf16 v[132:135], a[128:131], v[116:119], v[132:135]
    s_add_u32 s30, s23, 4096
    v_mfma_f32_16x16x32_bf16 v[136:139], a[132:135], v[112:115], v[136:139]
    s_add_u32 s25, s25, 32768
    ds_read_b64_tr_b16 a[156:157], v37 offset:256
    ds_read_b64_tr_b16 a[158:159], v37 offset:8448
    v_mfma_f32_16x16x32_bf16 v[140:143], a[132:135], v[116:119], v[140:143]
    s_waitcnt lgkmcnt(8)
    buffer_load_dwordx4 v2, s[8:11], s23 offen offset:0 nt lds
    v_mfma_f32_16x16x32_bf16 v[144:147], a[136:139], v[112:115], v[144:147]
    s_cmp_ge_u32 s25, 163840
    ds_read_b64_tr_b16 a[160:161], v30 offset:16640
    ds_read_b64_tr_b16 a[162:163], v30 offset:24832
    buffer_load_dwordx4 v3, s[8:11], s23 offen offset:1024 nt lds
    v_mfma_f32_16x16x32_bf16 v[148:151], a[136:139], v[116:119], v[148:151]
    s_cselect_b32 s25, 0, s25
    buffer_load_dwordx4 v4, s[8:11], s23 offen offset:2048 nt lds
    v_mfma_f32_16x16x32_bf16 v[152:155], a[140:143], v[112:115], v[152:155]
    ds_read_b64_tr_b16 a[164:165], v31 offset:16640
    ds_read_b64_tr_b16 a[166:167], v31 offset:24832
    v_mfma_f32_16x16x32_bf16 v[156:159], a[140:143], v[116:119], v[156:159]
    s_waitcnt lgkmcnt(8)
    buffer_load_dwordx4 v5, s[8:11], s23 offen offset:3072 nt lds
    v_mfma_f32_16x16x32_bf16 v[160:163], a[144:147], v[112:115], v[160:163]
    s_add_u32 m0, s26, 4096
    ds_read_b64_tr_b16 a[168:169], v32 offset:16640
    ds_read_b64_tr_b16 a[170:171], v32 offset:24832
    v_mfma_f32_16x16x32_bf16 v[164:167], a[144:147], v[116:119], v[164:167]
    s_add_u32 s23, s23, 32768
    v_max3_f32 v42, v80, v81, v82
    v_max3_f32 v43, v84, v85, v86
    v_mfma_f32_16x16x32_bf16 v[168:171], a[148:151], v[112:115], v[168:171]
    ds_read_b64_tr_b16 a[172:173], v33 offset:16640
    ds_read_b64_tr_b16 a[174:175], v33 offset:24832
    buffer_load_dwordx4 v6, s[8:11], s30 offen offset:0 nt lds
    v_mfma_f32_16x16x32_bf16 v[172:175], a[148:151], v[116:119], v[172:175]
    s_waitcnt lgkmcnt(8)
    buffer_load_dwordx4 v7, s[8:11], s30 offen offset:1024 nt lds
    v_mfma_f32_16x16x32_bf16 v[176:179], a[152:155], v[112:115], v[176:179]
    ds_read_b64_tr_b16 a[176:177], v34 offset:16640
    ds_read_b64_tr_b16 a[178:179], v34 offset:24832
    buffer_load_dwordx4 v8, s[8:11], s30 offen offset:2048 nt lds
    v_mfma_f32_16x16x32_bf16 v[180:183], a[152:155], v[116:119], v[180:183]
    buffer_load_dwordx4 v9, s[8:11], s30 offen offset:3072 nt lds
    v_mfma_f32_16x16x32_bf16 v[184:187], a[156:159], v[112:115], v[184:187]
    ds_read_b64_tr_b16 a[180:181], v35 offset:16640
    ds_read_b64_tr_b16 a[182:183], v35 offset:24832
    v_mfma_f32_16x16x32_bf16 v[188:191], a[156:159], v[116:119], v[188:191]
    s_waitcnt lgkmcnt(8)
    v_mfma_f32_16x16x32_bf16 v[128:131], a[160:163], v[120:123], v[128:131]
    ds_read_b64_tr_b16 a[184:185], v36 offset:16640
    ds_read_b64_tr_b16 a[186:187], v36 offset:24832
    v_mfma_f32_16x16x32_bf16 v[132:135], a[160:163], v[124:127], v[132:135]
    v_mfma_f32_16x16x32_bf16 v[136:139], a[164:167], v[120:123], v[136:139]
    ds_read_b64_tr_b16 a[188:189], v37 offset:16640
    ds_read_b64_tr_b16 a[190:191], v37 offset:24832
    v_mfma_f32_16x16x32_bf16 v[140:143], a[164:167], v[124:127], v[140:143]
    s_waitcnt lgkmcnt(8)
    v_mfma_f32_16x16x32_bf16 v[144:147], a[168:171], v[120:123], v[144:147]
    v_mfma_f32_16x16x32_bf16 v[148:151], a[168:171], v[124:127], v[148:151]
    v_max3_f32 v42, v83, v88, v42
    v_mfma_f32_16x16x32_bf16 v[152:155], a[172:175], v[120:123], v[152:155]
    v_max3_f32 v43, v87, v92, v43
    v_mfma_f32_16x16x32_bf16 v[156:159], a[172:175], v[124:127], v[156:159]
    s_waitcnt lgkmcnt(4)
    v_max3_f32 v42, v89, v90, v42
    v_mfma_f32_16x16x32_bf16 v[160:163], a[176:179], v[120:123], v[160:163]
    ds_read_b64_tr_b16 a[128:129], v30 offset:0
    ds_read_b64_tr_b16 a[130:131], v30 offset:8192
    v_mfma_f32_16x16x32_bf16 v[164:167], a[176:179], v[124:127], v[164:167]
    v_max3_f32 v43, v93, v94, v43
    v_mfma_f32_16x16x32_bf16 v[168:171], a[180:183], v[120:123], v[168:171]
    ds_read_b64_tr_b16 a[132:133], v31 offset:0
    ds_read_b64_tr_b16 a[134:135], v31 offset:8192
    v_mfma_f32_16x16x32_bf16 v[172:175], a[180:183], v[124:127], v[172:175]
    s_waitcnt lgkmcnt(4)
    v_max3_f32 v42, v91, v96, v42
    v_max3_f32 v43, v95, v100, v43
    v_mfma_f32_16x16x32_bf16 v[176:179], a[184:187], v[120:123], v[176:179]
    ds_read_b64_tr_b16 a[136:137], v32 offset:0
    ds_read_b64_tr_b16 a[138:139], v32 offset:8192
    v_mfma_f32_16x16x32_bf16 v[180:183], a[184:187], v[124:127], v[180:183]
    v_max3_f32 v42, v97, v98, v42
    v_max3_f32 v43, v101, v102, v43
    v_mfma_f32_16x16x32_bf16 v[184:187], a[188:191], v[120:123], v[184:187]
    ds_read_b64_tr_b16 a[140:141], v33 offset:0
    ds_read_b64_tr_b16 a[142:143], v33 offset:8192
    v_mfma_f32_16x16x32_bf16 v[188:191], a[188:191], v[124:127], v[188:191]
    v_max3_f32 v42, v99, v104, v42
    v_max3_f32 v43, v103, v108, v43
    v_mfma_f32_16x16x32_bf16 a[196:199], a[192:195], v[112:115], a[196:199]
    ds_read_b64_tr_b16 a[144:145], v34 offset:0
    ds_read_b64_tr_b16 a[146:147], v34 offset:8192
    v_mfma_f32_16x16x32_bf16 a[200:203], a[192:195], v[116:119], a[200:203]
    v_max3_f32 v42, v105, v106, v42
    v_max3_f32 v43, v109, v110, v43
    v_mfma_f32_16x16x32_bf16 a[196:199], a[192:195], v[120:123], a[196:199]
    ds_read_b64_tr_b16 a[148:149], v35 offset:0
    ds_read_b64_tr_b16 a[150:151], v35 offset:8192
    v_mfma_f32_16x16x32_bf16 a[200:203], a[192:195], v[124:127], a[200:203]
    s_waitcnt lgkmcnt(8)
    v_max_f32 v42, v107, v42
    v_max_f32 v43, v111, v43
    v_mfma_f32_16x16x32_bf16 a[0:3], a[128:131], v[112:115], a[0:3]
    ds_read_b64_tr_b16 a[152:153], v36 offset:0
    ds_read_b64_tr_b16 a[154:155], v36 offset:8192
    v_mfma_f32_16x16x32_bf16 a[4:7], a[128:131], v[116:119], a[4:7]
    v_max_f32 v44, v42, v43
    v_add_u32 v18, s25, v14
    v_add_u32 v19, s25, v15
    v_mfma_f32_16x16x32_bf16 a[8:11], a[132:135], v[112:115], a[8:11]
    ds_read_b64_tr_b16 a[156:157], v37 offset:0
    ds_read_b64_tr_b16 a[158:159], v37 offset:8192
    v_mfma_f32_16x16x32_bf16 a[12:15], a[132:135], v[116:119], a[12:15]
    s_waitcnt lgkmcnt(8)
    v_cmp_lt_f32 vcc, s22, v44
    v_add_u32 v20, s25, v16
    v_mfma_f32_16x16x32_bf16 a[16:19], a[136:139], v[112:115], a[16:19]
    s_cbranch_vccnz L_rare_0
L_back_0:
    ds_read_b64_tr_b16 a[160:161], v30 offset:16384
    ds_read_b64_tr_b16 a[162:163], v30 offset:24576
    v_mfma_f32_16x16x32_bf16 a[20:23], a[136:139], v[116:119], a[20:23]
    s_add_u32 s26, s26, 32768
    v_exp_f32 v80, v80
    v_mfma_f32_16x16x32_bf16 a[24:27], a[140:143], v[112:115], a[24:27]
    s_cmp_ge_u32 s26, 163840
    ds_read_b64_tr_b16 a[164:165], v31 offset:16384
    ds_read_b64_tr_b16 a[166:167], v31 offset:24576
    v_add_u32 v21, s25, v17
    v_mfma_f32_16x16x32_bf16 a[28:31], a[140:143], v[116:119], a[28:31]
    s_waitcnt lgkmcnt(8)
    v_exp_f32 v81, v81
    v_mfma_f32_16x16x32_bf16 a[32:35], a[144:147], v[112:115], a[32:35]
    s_cselect_b32 s26, s34, s26
    ds_read_b64_tr_b16 a[168:169], v32 offset:16384
    ds_read_b64_tr_b16 a[170:171], v32 offset:24576
    v_mfma_f32_16x16x32_bf16 a[36:39], a[144:147], v[116:119], a[36:39]
    v_exp_f32 v82, v82
    v_mfma_f32_16x16x32_bf16 a[40:43], a[148:151], v[112:115], a[40:43]
    ds_read_b64_tr_b16 a[172:173], v33 offset:16384
    ds_read_b64_tr_b16 a[174:175], v33 offset:24576
    v_mfma_f32_16x16x32_bf16 a[44:47], a[148:151], v[116:119], a[44:47]
    s_waitcnt lgkmcnt(8)
    v_exp_f32 v83, v83
    v_cvt_pk_bf16_f32 v192, v80, v81
    v_mfma_f32_16x16x32_bf16 a[48:51], a[152:155], v[112:115], a[48:51]
    ds_read_b64_tr_b16 a[176:177], v34 offset:16384
    ds_read_b64_tr_b16 a[178:179], v34 offset:24576
    v_mfma_f32_16x16x32_bf16 a[52:55], a[152:155], v[116:119], a[52:55]
    v_exp_f32 v84, v84
    v_mfma_f32_16x16x32_bf16 a[56:59], a[156:159], v[112:115], a[56:59]
    ds_read_b64_tr_b16 a[180:181], v35 offset:16384
    ds_read_b64_tr_b16 a[182:183], v35 offset:24576
    v_mfma_f32_16x16x32_bf16 a[60:63], a[156:159], v[116:119], a[60:63]
    s_waitcnt lgkmcnt(8)
    v_exp_f32 v85, v85
    v_mfma_f32_16x16x32_bf16 a[0:3], a[160:163], v[120:123], a[0:3]
    ds_read_b64_tr_b16 a[184:185], v36 offset:16384
    ds_read_b64_tr_b16 a[186:187], v36 offset:24576
    v_mfma_f32_16x16x32_bf16 a[4:7], a[160:163], v[124:127], a[4:7]
    v_exp_f32 v86, v86
    v_cvt_pk_bf16_f32 v193, v82, v83
    v_mfma_f32_16x16x32_bf16 a[8:11], a[164:167], v[120:123], a[8:11]
    ds_read_b64_tr_b16 a[188:189], v37 offset:16384
    ds_read_b64_tr_b16 a[190:191], v37 offset:24576
    v_mfma_f32_16x16x32_bf16 a[12:15], a[164:167], v[124:127], a[12:15]
    s_waitcnt lgkmcnt(8)
    v_exp_f32 v87, v87
    v_mfma_f32_16x16x32_bf16 a[16:19], a[168:171], v[120:123], a[16:19]
    s_waitcnt vmcnt(16)
    s_barrier
    ds_read_b128 a[128:131], v18 offset:0
    v_cvt_pk_bf16_f32 v196, v84, v85
    v_mfma_f32_16x16x32_bf16 a[20:23], a[168:171], v[124:127], a[20:23]
    v_exp_f32 v88, v88
    v_mfma_f32_16x16x32_bf16 a[24:27], a[172:175], v[120:123], a[24:27]
    ds_read_b128 a[132:135], v18 offset:8192
    v_cvt_pk_bf16_f32 v197, v86, v87
    v_mfma_f32_16x16x32_bf16 a[28:31], a[172:175], v[124:127], a[28:31]
    s_waitcnt lgkmcnt(6)
    v_exp_f32 v89, v89
    v_mfma_f32_16x16x32_bf16 a[32:35], a[176:179], v[120:123], a[32:35]
    ds_read_b128 a[136:139], v18 offset:16384
    v_cvt_pk_bf16_f32 v194, v88, v89
    v_mfma_f32_16x16x32_bf16 a[36:39], a[176:179], v[124:127], a[36:39]
    v_exp_f32 v90, v90
    v_mfma_f32_16x16x32_bf16 a[40:43], a[180:183], v[120:123], a[40:43]
    ds_read_b128 a[140:143], v18 offset:24576
    v_exp_f32 v91, v91
    v_mfma_f32_16x16x32_bf16 a[44:47], a[180:183], v[124:127], a[44:47]
    s_waitcnt lgkmcnt(4)
    v_exp_f32 v92, v92
    v_cvt_pk_bf16_f32 v195, v90, v91
    v_mfma_f32_16x16x32_bf16 a[48:51], a[184:187], v[120:123], a[48:51]
    ds_read_b128 a[144:147], v19 offset:0
    v_mfma_f32_16x16x32_bf16 a[52:55], a[184:187], v[124:127], a[52:55]
    v_exp_f32 v93, v93
    v_mfma_f32_16x16x32_bf16 a[56:59], a[188:191], v[120:123], a[56:59]
    ds_read_b128 a[148:151], v19 offset:8192
    v_cvt_pk_bf16_f32 v198, v92, v93
    v_mfma_f32_16x16x32_bf16 a[60:63], a[188:191], v[124:127], a[60:63]
    s_waitcnt lgkmcnt(4)
    v_exp_f32 v94, v94
    v_mfma_f32_16x16x32_bf16 v[48:51], a[128:131], a[64:67], v[244:247]
    s_mov_b32 m0, s26
    ds_read_b128 a[152:155], v19 offset:16384
    v_mfma_f32_16x16x32_bf16 v[52:55], a[128:131], a[68:71], v[248:251]
    s_add_u32 s30, s24, 4096
    v_exp_f32 v95, v95
    v_mfma_f32_16x16x32_bf16 v[56:59], a[132:135], a[64:67], v[244:247]
    s_add_u32 s25, s25, 32768
    ds_read_b128 a[156:159], v19 offset:24576
    v_cvt_pk_bf16_f32 v199, v94, v95
    v_mfma_f32_16x16x32_bf16 v[60:63], a[132:135], a[68:71], v[248:251]
    s_waitcnt lgkmcnt(4)
    buffer_load_dwordx4 v10, s[12:15], s24 offen offset:0 nt lds
    v_mfma_f32_16x16x32_bf16 v[64:67], a[136:139], a[64:67], v[244:247]
    s_cmp_ge_u32 s25, 163840
    ds_read_b128 a[160:163], v20 offset:0
    buffer_load_dwordx4 v11, s[12:15], s24 offen offset:1024 nt lds
    v_mfma_f32_16x16x32_bf16 v[68:71], a[136:139], a[68:71], v[248:251]
    s_cselect_b32 s25, 0, s25
    buffer_load_dwordx4 v12, s[12:15], s24 offen offset:2048 nt lds
    v_mfma_f32_16x16x32_bf16 v[72:75], a[140:143], a[64:67], v[244:247]
    ds_read_b128 a[164:167], v20 offset:8192
    v_add_u32 v30, s25, v22
    buffer_load_dwordx4 v13, s[12:15], s24 offen offset:3072 nt lds
    v_mfma_f32_16x16x32_bf16 v[76:79], a[140:143], a[68:71], v[248:251]
    s_waitcnt lgkmcnt(4)
    v_exp_f32 v96, v96
    v_mfma_f32_16x16x32_bf16 v[48:51], a[144:147], a[72:75], v[48:51]
    s_add_u32 m0, s26, 4096
    ds_read_b128 a[168:171], v20 offset:16384
    v_add_u32 v31, s25, v23
    v_mfma_f32_16x16x32_bf16 v[52:55], a[144:147], a[76:79], v[52:55]
    s_add_u32 s24, s24, 32768
    v_exp_f32 v97, v97
    v_mfma_f32_16x16x32_bf16 v[56:59], a[148:151], a[72:75], v[56:59]
    ds_read_b128 a[172:175], v20 offset:24576
    v_add_u32 v32, s25, v24
    buffer_load_dwordx4 v10, s[12:15], s30 offen offset:0 nt lds
    v_mfma_f32_16x16x32_bf16 v[60:63], a[148:151], a[76:79], v[60:63]
    s_waitcnt lgkmcnt(4)
    buffer_load_dwordx4 v11, s[12:15], s30 offen offset:1024 nt lds
    v_mfma_f32_16x16x32_bf16 v[64:67], a[152:155], a[72:75], v[64:67]
    ds_read_b128 a[176:179], v21 offset:0
    buffer_load_dwordx4 v12, s[12:15], s30 offen offset:2048 nt lds
    v_mfma_f32_16x16x32_bf16 v[68:71], a[152:155], a[76:79], v[68:71]
    buffer_load_dwordx4 v13, s[12:15], s30 offen offset:3072 nt lds
    v_mfma_f32_16x16x32_bf16 v[72:75], a[156:159], a[72:75], v[72:75]
    s_add_u32 s26, s26, 32768
    ds_read_b128 a[180:183], v21 offset:8192
    v_mfma_f32_16x16x32_bf16 v[76:79], a[156:159], a[76:79], v[76:79]
    s_waitcnt lgkmcnt(4)
    v_mfma_f32_16x16x32_bf16 v[48:51], a[160:163], a[80:83], v[48:51]
    s_cmp_ge_u32 s26, 163840
    ds_read_b128 a[184:187], v21 offset:16384
    v_mfma_f32_16x16x32_bf16 v[52:55], a[160:163], a[84:87], v[52:55]
    s_cselect_b32 s26, s34, s26
    v_add_u32 v33, s25, v25
    v_mfma_f32_16x16x32_bf16 v[56:59], a[164:167], a[80:83], v[56:59]
    ds_read_b128 a[188:191], v21 offset:24576
    v_mfma_f32_16x16x32_bf16 v[60:63], a[164:167], a[84:87], v[60:63]
    s_waitcnt lgkmcnt(4)
    v_add_u32 v34, s25, v26
    v_mfma_f32_16x16x32_bf16 v[64:67], a[168:171], a[80:83], v[64:67]
    ds_read_b128 a[128:131], v18 offset:256
    v_mfma_f32_16x16x32_bf16 v[68:71], a[168:171], a[84:87], v[68:71]
    v_add_u32 v35, s25, v27
    v_mfma_f32_16x16x32_bf16 v[72:75], a[172:175], a[80:83], v[72:75]
    ds_read_b128 a[132:135], v18 offset:8448
    v_add_u32 v36, s25, v28
    v_mfma_f32_16x16x32_bf16 v[76:79], a[172:175], a[84:87], v[76:79]
    s_waitcnt lgkmcnt(4)
    v_exp_f32 v98, v98
    v_mfma_f32_16x16x32_bf16 v[48:51], a[176:179], a[88:91], v[48:51]
    ds_read_b128 a[136:139], v18 offset:16640
    v_add_u32 v37, s25, v29
    v_mfma_f32_16x16x32_bf16 v[52:55], a[176:179], a[92:95], v[52:55]
    v_exp_f32 v99, v99
    v_mfma_f32_16x16x32_bf16 v[56:59], a[180:183], a[88:91], v[56:59]
    ds_read_b128 a[140:143], v18 offset:24832
    v_cvt_pk_bf16_f32 v200, v96, v97
    v_mfma_f32_16x16x32_bf16 v[60:63], a[180:183], a[92:95], v[60:63]
    s_waitcnt lgkmcnt(4)
    v_exp_f32 v100, v100
    v_mfma_f32_16x16x32_bf16 v[64:67], a[184:187], a[88:91], v[64:67]
    ds_read_b128 a[144:147], v19 offset:256
    v_cvt_pk_bf16_f32 v201, v98, v99
    v_mfma_f32_16x16x32_bf16 v[68:71], a[184:187], a[92:95], v[68:71]
    v_exp_f32 v101, v101
    v_mfma_f32_16x16x32_bf16 v[72:75], a[188:191], a[88:91], v[72:75]
    ds_read_b128 a[148:151], v19 offset:8448
    v_cvt_pk_bf16_f32 v204, v100, v101
    v_mfma_f32_16x16x32_bf16 v[76:79], a[188:191], a[92:95], v[76:79]
    s_waitcnt lgkmcnt(4)
    v_exp_f32 v102, v102
    v_mfma_f32_16x16x32_bf16 v[48:51], a[128:131], a[96:99], v[48:51]
    ds_read_b128 a[152:155], v19 offset:16640
    v_mfma_f32_16x16x32_bf16 v[52:55], a[128:131], a[100:103], v[52:55]
    v_exp_f32 v103, v103
    v_mfma_f32_16x16x32_bf16 v[56:59], a[132:135], a[96:99], v[56:59]
    ds_read_b128 a[156:159], v19 offset:24832
    v_cvt_pk_bf16_f32 v205, v102, v103
    v_mfma_f32_16x16x32_bf16 v[60:63], a[132:135], a[100:103], v[60:63]
    s_waitcnt lgkmcnt(4)
    v_exp_f32 v104, v104
    v_mfma_f32_16x16x32_bf16 v[64:67], a[136:139], a[96:99], v[64:67]
    ds_read_b128 a[160:163], v20 offset:256
    v_exp_f32 v105, v105
    v_mfma_f32_16x16x32_bf16 v[68:71], a[136:139], a[100:103], v[68:71]
    v_exp_f32 v106, v106
    v_mfma_f32_16x16x32_bf16 v[72:75], a[140:143], a[96:99], v[72:75]
    ds_read_b128 a[164:167], v20 offset:8448
    v_cvt_pk_bf16_f32 v202, v104, v105
    v_mfma_f32_16x16x32_bf16 v[76:79], a[140:143], a[100:103], v[76:79]
    s_waitcnt lgkmcnt(4)
    v_exp_f32 v107, v107
    v_mfma_f32_16x16x32_bf16 v[48:51], a[144:147], a[104:107], v[48:51]
    ds_read_b128 a[168:171], v20 offset:16640
    v_cvt_pk_bf16_f32 v203, v106, v107
    v_mfma_f32_16x16x32_bf16 v[52:55], a[144:147], a[108:111], v[52:55]
    v_exp_f32 v108, v108
    v_mfma_f32_16x16x32_bf16 v[56:59], a[148:151], a[104:107], v[56:59]
    ds_read_b128 a[172:175], v20 offset:24832
    v_exp_f32 v109, v109
    v_mfma_f32_16x16x32_bf16 v[60:63], a[148:151], a[108:111], v[60:63]
    s_waitcnt lgkmcnt(4)
    v_exp_f32 v110, v110
    v_cvt_pk_bf16_f32 v206, v108, v109
    v_mfma_f32_16x16x32_bf16 v[64:67], a[152:155], a[104:107], v[64:67]
    ds_read_b128 a[176:179], v21 offset:256
    v_mfma_f32_16x16x32_bf16 v[68:71], a[152:155], a[108:111], v[68:71]
    v_exp_f32 v111, v111
    v_mfma_f32_16x16x32_bf16 v[72:75], a[156:159], a[104:107], v[72:75]
    ds_read_b128 a[180:183], v21 offset:8448
    v_cvt_pk_bf16_f32 v207, v110, v111
    v_mfma_f32_16x16x32_bf16 v[76:79], a[156:159], a[108:111], v[76:79]
    s_waitcnt lgkmcnt(4)
    v_mfma_f32_16x16x32_bf16 v[48:51], a[160:163], a[112:115], v[48:51]
    ds_read_b128 a[184:187], v21 offset:16640
    v_mfma_f32_16x16x32_bf16 v[52:55], a[160:163], a[116:119], v[52:55]
    v_mfma_f32_16x16x32_bf16 v[56:59], a[164:167], a[112:115], v[56:59]
    ds_read_b128 a[188:191], v21 offset:24832
    v_mfma_f32_16x16x32_bf16 v[60:63], a[164:167], a[116:119], v[60:63]
    s_waitcnt lgkmcnt(4)
    v_mfma_f32_16x16x32_bf16 v[64:67], a[168:171], a[112:115], v[64:67]
    s_waitcnt vmcnt(16)
    s_barrier
    ds_read_b64_tr_b16 a[128:129], v30 offset:256
    ds_read_b64_tr_b16 a[130:131], v30 offset:8448
    v_mfma_f32_16x16x32_bf16 v[68:71], a[168:171], a[116:119], v[68:71]
    v_mfma_f32_16x16x32_bf16 v[72:75], a[172:175], a[112:115], v[72:75]
    ds_read_b64_tr_b16 a[132:133], v31 offset:256
    ds_read_b64_tr_b16 a[134:135], v31 offset:8448
    v_mfma_f32_16x16x32_bf16 v[76:79], a[172:175], a[116:119], v[76:79]
    s_waitcnt lgkmcnt(6)
    v_mfma_f32_16x16x32_bf16 v[48:51], a[176:179], a[120:123], v[48:51]
    ds_read_b64_tr_b16 a[136:137], v32 offset:256
    ds_read_b64_tr_b16 a[138:139], v32 offset:8448
    v_mfma_f32_16x16x32_bf16 v[52:55], a[176:179], a[124:127], v[52:55]
    v_mfma_f32_16x16x32_bf16 v[56:59], a[180:183], a[120:123], v[56:59]
    ds_read_b64_tr_b16 a[140:141], v33 offset:256
    ds_read_b64_tr_b16 a[142:143], v33 offset:8448
    v_mfma_f32_16x16x32_bf16 v[60:63], a[180:183], a[124:127], v[60:63]
    s_waitcnt lgkmcnt(8)
    v_mfma_f32_16x16x32_bf16 v[64:67], a[184:187], a[120:123], v[64:67]
    ds_read_b64_tr_b16 a[144:145], v34 offset:256
    ds_read_b64_tr_b16 a[146:147], v34 offset:8448
    v_mfma_f32_16x16x32_bf16 v[68:71], a[184:187], a[124:127], v[68:71]
    v_mfma_f32_16x16x32_bf16 v[72:75], a[188:191], a[120:123], v[72:75]
    ds_read_b64_tr_b16 a[148:149], v35 offset:256
    ds_read_b64_tr_b16 a[150:151], v35 offset:8448
    v_mfma_f32_16x16x32_bf16 v[76:79], a[188:191], a[124:127], v[76:79]
    s_waitcnt lgkmcnt(8)
    v_mfma_f32_16x16x32_bf16 v[128:131], a[128:131], v[192:195], v[128:131]
    s_mov_b32 m0, s26
    ds_read_b64_tr_b16 a[152:153], v36 offset:256
    ds_read_b64_tr_b16 a[154:155], v36 offset:8448
    v_mfma_f32_16x16x32_bf16 v[132:135], a[128:131], v[196:199], v[132:135]
    s_add_u32 s30, s23, 4096
    v_mfma_f32_16x16x32_bf16 v[136:139], a[132:135], v[192:195], v[136:139]
    s_add_u32 s25, s25, 32768
    ds_read_b64_tr_b16 a[156:157], v37 offset:256
    ds_read_b64_tr_b16 a[158:159], v37 offset:8448
    v_mfma_f32_16x16x32_bf16 v[140:143], a[132:135], v[196:199], v[140:143]
    s_waitcnt lgkmcnt(8)
    buffer_load_dwordx4 v2, s[8:11], s23 offen offset:0 nt lds
    v_mfma_f32_16x16x32_bf16 v[144:147], a[136:139], v[192:195], v[144:147]
    s_cmp_ge_u32 s25, 163840
    ds_read_b64_tr_b16 a[160:161], v30 offset:16640
    ds_read_b64_tr_b16 a[162:163], v30 offset:24832
    buffer_load_dwordx4 v3, s[8:11], s23 offen offset:1024 nt lds
    v_mfma_f32_16x16x32_bf16 v[148:151], a[136:139], v[196:199], v[148:151]
    s_cselect_b32 s25, 0, s25
    buffer_load_dwordx4 v4, s[8:11], s23 offen offset:2048 nt lds
    v_mfma_f32_16x16x32_bf16 v[152:155], a[140:143], v[192:195], v[152:155]
    ds_read_b64_tr_b16 a[164:165], v31 offset:16640
    ds_read_b64_tr_b16 a[166:167], v31 offset:24832
    v_mfma_f32_16x16x32_bf16 v[156:159], a[140:143], v[196:199], v[156:159]
    s_waitcnt lgkmcnt(8)
    buffer_load_dwordx4 v5, s[8:11], s23 offen offset:3072 nt lds
    v_mfma_f32_16x16x32_bf16 v[160:163], a[144:147], v[192:195], v[160:163]
    s_add_u32 m0, s26, 4096
    ds_read_b64_tr_b16 a[168:169], v32 offset:16640
    ds_read_b64_tr_b16 a[170:171], v32 offset:24832
    v_mfma_f32_16x16x32_bf16 v[164:167], a[144:147], v[196:199], v[164:167]
    s_add_u32 s23, s23, 32768
    v_max3_f32 v42, v48, v49, v50
    v_max3_f32 v43, v52, v53, v54
    v_mfma_f32_16x16x32_bf16 v[168:171], a[148:151], v[192:195], v[168:171]
    ds_read_b64_tr_b16 a[172:173], v33 offset:16640
    ds_read_b64_tr_b16 a[174:175], v33 offset:24832
    buffer_load_dwordx4 v6, s[8:11], s30 offen offset:0 nt lds
    v_mfma_f32_16x16x32_bf16 v[172:175], a[148:151], v[196:199], v[172:175]
    s_waitcnt lgkmcnt(8)
    buffer_load_dwordx4 v7, s[8:11], s30 offen offset:1024 nt lds
    v_mfma_f32_16x16x32_bf16 v[176:179], a[152:155], v[192:195], v[176:179]
    ds_read_b64_tr_b16 a[176:177], v34 offset:16640
    ds_read_b64_tr_b16 a[178:179], v34 offset:24832
    buffer_load_dwordx4 v8, s[8:11], s30 offen offset:2048 nt lds
    v_mfma_f32_16x16x32_bf16 v[180:183], a[152:155], v[196:199], v[180:183]
    buffer_load_dwordx4 v9, s[8:11], s30 offen offset:3072 nt lds
    v_mfma_f32_16x16x32_bf16 v[184:187], a[156:159], v[192:195], v[184:187]
    ds_read_b64_tr_b16 a[180:181], v35 offset:16640
    ds_read_b64_tr_b16 a[182:183], v35 offset:24832
    v_mfma_f32_16x16x32_bf16 v[188:191], a[156:159], v[196:199], v[188:191]
    s_waitcnt lgkmcnt(8)
    v_mfma_f32_16x16x32_bf16 v[128:131], a[160:163], v[200:203], v[128:131]
    ds_read_b64_tr_b16 a[184:185], v36 offset:16640
    ds_read_b64_tr_b16 a[186:187], v36 offset:24832
    v_mfma_f32_16x16x32_bf16 v[132:135], a[160:163], v[204:207], v[132:135]
    v_mfma_f32_16x16x32_bf16 v[136:139], a[164:167], v[200:203], v[136:139]
    ds_read_b64_tr_b16 a[188:189], v37 offset:16640
    ds_read_b64_tr_b16 a[190:191], v37 offset:24832
    v_mfma_f32_16x16x32_bf16 v[140:143], a[164:167], v[204:207], v[140:143]
    s_waitcnt lgkmcnt(8)
    v_mfma_f32_16x16x32_bf16 v[144:147], a[168:171], v[200:203], v[144:147]
    v_mfma_f32_16x16x32_bf16 v[148:151], a[168:171], v[204:207], v[148:151]
    v_max3_f32 v42, v51, v56, v42
    v_mfma_f32_16x16x32_bf16 v[152:155], a[172:175], v[200:203], v[152:155]
    v_max3_f32 v43, v55, v60, v43
    v_mfma_f32_16x16x32_bf16 v[156:159], a[172:175], v[204:207], v[156:159]
    s_waitcnt lgkmcnt(4)
    v_max3_f32 v42, v57, v58, v42
    v_mfma_f32_16x16x32_bf16 v[160:163], a[176:179], v[200:203], v[160:163]
    ds_read_b64_tr_b16 a[128:129], v30 offset:0
    ds_read_b64_tr_b16 a[130:131], v30 offset:8192
    v_mfma_f32_16x16x32_bf16 v[164:167], a[176:179], v[204:207], v[164:167]
    v_max3_f32 v43, v61, v62, v43
    v_mfma_f32_16x16x32_bf16 v[168:171], a[180:183], v[200:203], v[168:171]
    ds_read_b64_tr_b16 a[132:133], v31 offset:0
    ds_read_b64_tr_b16 a[134:135], v31 offset:8192
    v_mfma_f32_16x16x32_bf16 v[172:175], a[180:183], v[204:207], v[172:175]
    s_waitcnt lgkmcnt(4)
    v_max3_f32 v42, v59, v64, v42
    v_max3_f32 v43, v63, v68, v43
    v_mfma_f32_16x16x32_bf16 v[176:179], a[184:187], v[200:203], v[176:179]
    ds_read_b64_tr_b16 a[136:137], v32 offset:0
    ds_read_b64_tr_b16 a[138:139], v32 offset:8192
    v_mfma_f32_16x16x32_bf16 v[180:183], a[184:187], v[204:207], v[180:183]
    v_max3_f32 v42, v65, v66, v42
    v_max3_f32 v43, v69, v70, v43
    v_mfma_f32_16x16x32_bf16 v[184:187], a[188:191], v[200:203], v[184:187]
    ds_read_b64_tr_b16 a[140:141], v33 offset:0
    ds_read_b64_tr_b16 a[142:143], v33 offset:8192
    v_mfma_f32_16x16x32_bf16 v[188:191], a[188:191], v[204:207], v[188:191]
    v_max3_f32 v42, v67, v72, v42
    v_max3_f32 v43, v71, v76, v43
    v_mfma_f32_16x16x32_bf16 a[196:199], a[192:195], v[192:195], a[196:199]
    ds_read_b64_tr_b16 a[144:145], v34 offset:0
    ds_read_b64_tr_b16 a[146:147], v34 offset:8192
    v_mfma_f32_16x16x32_bf16 a[200:203], a[192:195], v[196:199], a[200:203]
    v_max3_f32 v42, v73, v74, v42
    v_max3_f32 v43, v77, v78, v43
    v_mfma_f32_16x16x32_bf16 a[196:199], a[192:195], v[200:203], a[196:199]
    ds_read_b64_tr_b16 a[148:149], v35 offset:0
    ds_read_b64_tr_b16 a[150:151], v35 offset:8192
    v_mfma_f32_16x16x32_bf16 a[200:203], a[192:195], v[204:207], a[200:203]
    s_waitcnt lgkmcnt(8)
    v_max_f32 v42, v75, v42
    v_max_f32 v43, v79, v43
    v_mfma_f32_16x16x32_bf16 a[0:3], a[128:131], v[192:195], a[0:3]
    ds_read_b64_tr_b16 a[152:153], v36 offset:0
    ds_read_b64_tr_b16 a[154:155], v36 offset:8192
    v_mfma_f32_16x16x32_bf16 a[4:7], a[128:131], v[196:199], a[4:7]
    v_max_f32 v44, v42, v43
    v_add_u32 v18, s25, v14
    v_add_u32 v19, s25, v15
    v_mfma_f32_16x16x32_bf16 a[8:11], a[132:135], v[192:195], a[8:11]
    ds_read_b64_tr_b16 a[156:157], v37 offset:0
    ds_read_b64_tr_b16 a[158:159], v37 offset:8192
    v_mfma_f32_16x16x32_bf16 a[12:15], a[132:135], v[196:199], a[12:15]
    s_waitcnt lgkmcnt(8)
    v_cmp_lt_f32 vcc, s22, v44
    v_add_u32 v20, s25, v16
    v_mfma_f32_16x16x32_bf16 a[16:19], a[136:139], v[192:195], a[16:19]
    s_cbranch_vccnz L_rare_1
L_back_1:
    ds_read_b64_tr_b16 a[160:161], v30 offset:16384
    ds_read_b64_tr_b16 a[162:163], v30 offset:24576
    v_mfma_f32_16x16x32_bf16 a[20:23], a[136:139], v[196:199], a[20:23]
    s_add_u32 s26, s26, 32768
    v_exp_f32 v48, v48
    v_mfma_f32_16x16x32_bf16 a[24:27], a[140:143], v[192:195], a[24:27]
    s_cmp_ge_u32 s26, 163840
    ds_read_b64_tr_b16 a[164:165], v31 offset:16384
    ds_read_b64_tr_b16 a[166:167], v31 offset:24576
    v_add_u32 v21, s25, v17
    v_mfma_f32_16x16x32_bf16 a[28:31], a[140:143], v[196:199], a[28:31]
    s_waitcnt lgkmcnt(8)
    v_exp_f32 v49, v49
    v_mfma_f32_16x16x32_bf16 a[32:35], a[144:147], v[192:195], a[32:35]
    s_cselect_b32 s26, s34, s26
    ds_read_b64_tr_b16 a[168:169], v32 offset:16384
    ds_read_b64_tr_b16 a[170:171], v32 offset:24576
    v_mfma_f32_16x16x32_bf16 a[36:39], a[144:147], v[196:199], a[36:39]
    v_exp_f32 v50, v50
    v_mfma_f32_16x16x32_bf16 a[40:43], a[148:151], v[192:195], a[40:43]
    ds_read_b64_tr_b16 a[172:173], v33 offset:16384
    ds_read_b64_tr_b16 a[174:175], v33 offset:24576
    v_mfma_f32_16x16x32_bf16 a[44:47], a[148:151], v[196:199], a[44:47]
    s_waitcnt lgkmcnt(8)
    v_exp_f32 v51, v51
    v_cvt_pk_bf16_f32 v112, v48, v49
    v_mfma_f32_16x16x32_bf16 a[48:51], a[152:155], v[192:195], a[48:51]
    ds_read_b64_tr_b16 a[176:177], v34 offset:16384
    ds_read_b64_tr_b16 a[178:179], v34 offset:24576
    v_mfma_f32_16x16x32_bf16 a[52:55], a[152:155], v[196:199], a[52:55]
    v_exp_f32 v52, v52
    v_mfma_f32_16x16x32_bf16 a[56:59], a[156:159], v[192:195], a[56:59]
    ds_read_b64_tr_b16 a[180:181], v35 offset:16384
    ds_read_b64_tr_b16 a[182:183], v35 offset:24576
    v_mfma_f32_16x16x32_bf16 a[60:63], a[156:159], v[196:199], a[60:63]
    s_waitcnt lgkmcnt(8)
    v_exp_f32 v53, v53
    v_mfma_f32_16x16x32_bf16 a[0:3], a[160:163], v[200:203], a[0:3]
    ds_read_b64_tr_b16 a[184:185], v36 offset:16384
    ds_read_b64_tr_b16 a[186:187], v36 offset:24576
    v_mfma_f32_16x16x32_bf16 a[4:7], a[160:163], v[204:207], a[4:7]
    v_exp_f32 v54, v54
    v_cvt_pk_bf16_f32 v113, v50, v51
    v_mfma_f32_16x16x32_bf16 a[8:11], a[164:167], v[200:203], a[8:11]
    ds_read_b64_tr_b16 a[188:189], v37 offset:16384
    ds_read_b64_tr_b16 a[190:191], v37 offset:24576
    v_mfma_f32_16x16x32_bf16 a[12:15], a[164:167], v[204:207], a[12:15]
    s_waitcnt lgkmcnt(8)
    v_exp_f32 v55, v55
    v_mfma_f32_16x16x32_bf16 a[16:19], a[168:171], v[200:203], a[16:19]
    s_waitcnt vmcnt(16)
    s_barrier
    ds_read_b128 a[128:131], v18 offset:0
    v_cvt_pk_bf16_f32 v116, v52, v53
    v_mfma_f32_16x16x32_bf16 a[20:23], a[168:171], v[204:207], a[20:23]
    v_exp_f32 v56, v56
    v_mfma_f32_16x16x32_bf16 a[24:27], a[172:175], v[200:203], a[24:27]
    ds_read_b128 a[132:135], v18 offset:8192
    v_cvt_pk_bf16_f32 v117, v54, v55
    v_mfma_f32_16x16x32_bf16 a[28:31], a[172:175], v[204:207], a[28:31]
    s_waitcnt lgkmcnt(6)
    v_exp_f32 v57, v57
    v_mfma_f32_16x16x32_bf16 a[32:35], a[176:179], v[200:203], a[32:35]
    ds_read_b128 a[136:139], v18 offset:16384
    v_cvt_pk_bf16_f32 v114, v56, v57
    v_mfma_f32_16x16x32_bf16 a[36:39], a[176:179], v[204:207], a[36:39]
    v_exp_f32 v58, v58
    v_mfma_f32_16x16x32_bf16 a[40:43], a[180:183], v[200:203], a[40:43]
    ds_read_b128 a[140:143], v18 offset:24576
    v_exp_f32 v59, v59
    v_mfma_f32_16x16x32_bf16 a[44:47], a[180:183], v[204:207], a[44:47]
    s_waitcnt lgkmcnt(4)
    v_exp_f32 v60, v60
    v_cvt_pk_bf16_f32 v115, v58, v59
    v_mfma_f32_16x16x32_bf16 a[48:51], a[184:187], v[200:203], a[48:51]
    ds_read_b128 a[144:147], v19 offset:0
    v_mfma_f32_16x16x32_bf16 a[52:55], a[184:187], v[204:207], a[52:55]
    v_exp_f32 v61, v61
    v_mfma_f32_16x16x32_bf16 a[56:59], a[188:191], v[200:203], a[56:59]
    ds_read_b128 a[148:151], v19 offset:8192
    v_cvt_pk_bf16_f32 v118, v60, v61
    v_mfma_f32_16x16x32_bf16 a[60:63], a[188:191], v[204:207], a[60:63]
    s_waitcnt lgkmcnt(4)
    v_exp_f32 v62, v62
    v_mfma_f32_16x16x32_bf16 v[80:83], a[128:131], a[64:67], v[244:247]
    s_mov_b32 m0, s26
    ds_read_b128 a[152:155], v19 offset:16384
    v_mfma_f32_16x16x32_bf16 v[84:87], a[128:131], a[68:71], v[248:251]
    s_add_u32 s30, s24, 4096
    v_exp_f32 v63, v63
    v_mfma_f32_16x16x32_bf16 v[88:91], a[132:135], a[64:67], v[244:247]
    s_add_u32 s25, s25, 32768
    ds_read_b128 a[156:159], v19 offset:24576
    v_cvt_pk_bf16_f32 v119, v62, v63
    v_mfma_f32_16x16x32_bf16 v[92:95], a[132:135], a[68:71], v[248:251]
    s_waitcnt lgkmcnt(4)
    buffer_load_dwordx4 v10, s[12:15], s24 offen offset:0 nt lds
    v_mfma_f32_16x16x32_bf16 v[96:99], a[136:139], a[64:67], v[244:247]
    s_cmp_ge_u32 s25, 163840
    ds_read_b128 a[160:163], v20 offset:0
    buffer_load_dwordx4 v11, s[12:15], s24 offen offset:1024 nt lds
    v_mfma_f32_16x16x32_bf16 v[100:103], a[136:139], a[68:71], v[248:251]
    s_cselect_b32 s25, 0, s25
    buffer_load_dwordx4 v12, s[12:15], s24 offen offset:2048 nt lds
    v_mfma_f32_16x16x32_bf16 v[104:107], a[140:143], a[64:67], v[244:247]
    ds_read_b128 a[164:167], v20 offset:8192
    v_add_u32 v30, s25, v22
    buffer_load_dwordx4 v13, s[12:15], s24 offen offset:3072 nt lds
    v_mfma_f32_16x16x32_bf16 v[108:111], a[140:143], a[68:71], v[248:251]
    s_waitcnt lgkmcnt(4)
    v_exp_f32 v64, v64
    v_mfma_f32_16x16x32_bf16 v[80:83], a[144:147], a[72:75], v[80:83]
    s_add_u32 m0, s26, 4096
    ds_read_b128 a[168:171], v20 offset:16384
    v_add_u32 v31, s25, v23
    v_mfma_f32_16x16x32_bf16 v[84:87], a[144:147], a[76:79], v[84:87]
    s_add_u32 s24, s24, 32768
    v_exp_f32 v65, v65
    v_mfma_f32_16x16x32_bf16 v[88:91], a[148:151], a[72:75], v[88:91]
    ds_read_b128 a[172:175], v20 offset:24576
    v_add_u32 v32, s25, v24
    buffer_load_dwordx4 v10, s[12:15], s30 offen offset:0 nt lds
    v_mfma_f32_16x16x32_bf16 v[92:95], a[148:151], a[76:79], v[92:95]
    s_waitcnt lgkmcnt(4)
    buffer_load_dwordx4 v11, s[12:15], s30 offen offset:1024 nt lds
    v_mfma_f32_16x16x32_bf16 v[96:99], a[152:155], a[72:75], v[96:99]
    ds_read_b128 a[176:179], v21 offset:0
    buffer_load_dwordx4 v12, s[12:15], s30 offen offset:2048 nt lds
    v_mfma_f32_16x16x32_bf16 v[100:103], a[152:155], a[76:79], v[100:103]
    buffer_load_dwordx4 v13, s[12:15], s30 offen offset:3072 nt lds
    v_mfma_f32_16x16x32_bf16 v[104:107], a[156:159], a[72:75], v[104:107]
    s_add_u32 s26, s26, 32768
    ds_read_b128 a[180:183], v21 offset:8192
    v_mfma_f32_16x16x32_bf16 v[108:111], a[156:159], a[76:79], v[108:111]
    s_waitcnt lgkmcnt(4)
    v_mfma_f32_16x16x32_bf16 v[80:83], a[160:163], a[80:83], v[80:83]
    s_cmp_ge_u32 s26, 163840
    ds_read_b128 a[184:187], v21 offset:16384
    v_mfma_f32_16x16x32_bf16 v[84:87], a[160:163], a[84:87], v[84:87]
    s_cselect_b32 s26, s34, s26
    v_add_u32 v33, s25, v25
    v_mfma_f32_16x16x32_bf16 v[88:91], a[164:167], a[80:83], v[88:91]
    ds_read_b128 a[188:191], v21 offset:24576
    v_mfma_f32_16x16x32_bf16 v[92:95], a[164:167], a[84:87], v[92:95]
    s_waitcnt lgkmcnt(4)
    v_add_u32 v34, s25, v26
    v_mfma_f32_16x16x32_bf16 v[96:99], a[168:171], a[80:83], v[96:99]
    ds_read_b128 a[128:131], v18 offset:256
    v_mfma_f32_16x16x32_bf16 v[100:103], a[168:171], a[84:87], v[100:103]
    v_add_u32 v35, s25, v27
    v_mfma_f32_16x16x32_bf16 v[104:107], a[172:175], a[80:83], v[104:107]
    ds_read_b128 a[132:135], v18 offset:8448
    v_add_u32 v36, s25, v28
    v_mfma_f32_16x16x32_bf16 v[108:111], a[172:175], a[84:87], v[108:111]
    s_waitcnt lgkmcnt(4)
    v_exp_f32 v66, v66
    v_mfma_f32_16x16x32_bf16 v[80:83], a[176:179], a[88:91], v[80:83]
    ds_read_b128 a[136:139], v18 offset:16640
    v_add_u32 v37, s25, v29
    v_mfma_f32_16x16x32_bf16 v[84:87], a[176:179], a[92:95], v[84:87]
    v_exp_f32 v67, v67
    v_mfma_f32_16x16x32_bf16 v[88:91], a[180:183], a[88:91], v[88:91]
    ds_read_b128 a[140:143], v18 offset:24832
    v_cvt_pk_bf16_f32 v120, v64, v65
    v_mfma_f32_16x16x32_bf16 v[92:95], a[180:183], a[92:95], v[92:95]
    s_waitcnt lgkmcnt(4)
    v_exp_f32 v68, v68
    v_mfma_f32_16x16x32_bf16 v[96:99], a[184:187], a[88:91], v[96:99]
    ds_read_b128 a[144:147], v19 offset:256
    v_cvt_pk_bf16_f32 v121, v66, v67
    v_mfma_f32_16x16x32_bf16 v[100:103], a[184:187], a[92:95], v[100:103]
    v_exp_f32 v69, v69
    v_mfma_f32_16x16x32_bf16 v[104:107], a[188:191], a[88:91], v[104:107]
    ds_read_b128 a[148:151], v19 offset:8448
    v_cvt_pk_bf16_f32 v124, v68, v69
    v_mfma_f32_16x16x32_bf16 v[108:111], a[188:191], a[92:95], v[108:111]
    s_waitcnt lgkmcnt(4)
    v_exp_f32 v70, v70
    v_mfma_f32_16x16x32_bf16 v[80:83], a[128:131], a[96:99], v[80:83]
    ds_read_b128 a[152:155], v19 offset:16640
    v_mfma_f32_16x16x32_bf16 v[84:87], a[128:131], a[100:103], v[84:87]
    v_exp_f32 v71, v71
    v_mfma_f32_16x16x32_bf16 v[88:91], a[132:135], a[96:99], v[88:91]
    ds_read_b128 a[156:159], v19 offset:24832
    v_cvt_pk_bf16_f32 v125, v70, v71
    v_mfma_f32_16x16x32_bf16 v[92:95], a[132:135], a[100:103], v[92:95]
    s_waitcnt lgkmcnt(4)
    v_exp_f32 v72, v72
    v_mfma_f32_16x16x32_bf16 v[96:99], a[136:139], a[96:99], v[96:99]
    ds_read_b128 a[160:163], v20 offset:256
    v_exp_f32 v73, v73
    v_mfma_f32_16x16x32_bf16 v[100:103], a[136:139], a[100:103], v[100:103]
    v_exp_f32 v74, v74
    v_mfma_f32_16x16x32_bf16 v[104:107], a[140:143], a[96:99], v[104:107]
    ds_read_b128 a[164:167], v20 offset:8448
    v_cvt_pk_bf16_f32 v122, v72, v73
    v_mfma_f32_16x16x32_bf16 v[108:111], a[140:143], a[100:103], v[108:111]
    s_waitcnt lgkmcnt(4)
    v_exp_f32 v75, v75
    v_mfma_f32_16x16x32_bf16 v[80:83], a[144:147], a[104:107], v[80:83]
    ds_read_b128 a[168:171], v20 offset:16640
    v_cvt_pk_bf16_f32 v123, v74, v75
    v_mfma_f32_16x16x32_bf16 v[84:87], a[144:147], a[108:111], v[84:87]
    v_exp_f32 v76, v76
    v_mfma_f32_16x16x32_bf16 v[88:91], a[148:151], a[104:107], v[88:91]
    ds_read_b128 a[172:175], v20 offset:24832
    v_exp_f32 v77, v77
    v_mfma_f32_16x16x32_bf16 v[92:95], a[148:151], a[108:111], v[92:95]
    s_waitcnt lgkmcnt(4)
    v_exp_f32 v78, v78
    v_cvt_pk_bf16_f32 v126, v76, v77
    v_mfma_f32_16x16x32_bf16 v[96:99], a[152:155], a[104:107], v[96:99]
    ds_read_b128 a[176:179], v21 offset:256
    v_mfma_f32_16x16x32_bf16 v[100:103], a[152:155], a[108:111], v[100:103]
    v_exp_f32 v79, v79
    v_mfma_f32_16x16x32_bf16 v[104:107], a[156:159], a[104:107], v[104:107]
    ds_read_b128 a[180:183], v21 offset:8448
    v_cvt_pk_bf16_f32 v127, v78, v79
    v_mfma_f32_16x16x32_bf16 v[108:111], a[156:159], a[108:111], v[108:111]
    s_waitcnt lgkmcnt(4)
    v_mfma_f32_16x16x32_bf16 v[80:83], a[160:163], a[112:115], v[80:83]
    ds_read_b128 a[184:187], v21 offset:16640
    v_mfma_f32_16x16x32_bf16 v[84:87], a[160:163], a[116:119], v[84:87]
    v_mfma_f32_16x16x32_bf16 v[88:91], a[164:167], a[112:115], v[88:91]
    ds_read_b128 a[188:191], v21 offset:24832
    v_mfma_f32_16x16x32_bf16 v[92:95], a[164:167], a[116:119], v[92:95]
    s_waitcnt lgkmcnt(4)
    v_mfma_f32_16x16x32_bf16 v[96:99], a[168:171], a[112:115], v[96:99]
    s_waitcnt vmcnt(16)
    s_barrier
    ds_read_b64_tr_b16 a[128:129], v30 offset:256
    ds_read_b64_tr_b16 a[130:131], v30 offset:8448
    v_mfma_f32_16x16x32_bf16 v[100:103], a[168:171], a[116:119], v[100:103]
    v_mfma_f32_16x16x32_bf16 v[104:107], a[172:175], a[112:115], v[104:107]
    ds_read_b64_tr_b16 a[132:133], v31 offset:256
    ds_read_b64_tr_b16 a[134:135], v31 offset:8448
    v_mfma_f32_16x16x32_bf16 v[108:111], a[172:175], a[116:119], v[108:111]
    s_waitcnt lgkmcnt(6)
    v_mfma_f32_16x16x32_bf16 v[80:83], a[176:179], a[120:123], v[80:83]
    ds_read_b64_tr_b16 a[136:137], v32 offset:256
    ds_read_b64_tr_b16 a[138:139], v32 offset:8448
    v_mfma_f32_16x16x32_bf16 v[84:87], a[176:179], a[124:127], v[84:87]
    v_mfma_f32_16x16x32_bf16 v[88:91], a[180:183], a[120:123], v[88:91]
    ds_read_b64_tr_b16 a[140:141], v33 offset:256
    ds_read_b64_tr_b16 a[142:143], v33 offset:8448
    v_mfma_f32_16x16x32_bf16 v[92:95], a[180:183], a[124:127], v[92:95]
    s_waitcnt lgkmcnt(8)
    v_mfma_f32_16x16x32_bf16 v[96:99], a[184:187], a[120:123], v[96:99]
    ds_read_b64_tr_b16 a[144:145], v34 offset:256
    ds_read_b64_tr_b16 a[146:147], v34 offset:8448
    v_mfma_f32_16x16x32_bf16 v[100:103], a[184:187], a[124:127], v[100:103]
    v_mfma_f32_16x16x32_bf16 v[104:107], a[188:191], a[120:123], v[104:107]
    ds_read_b64_tr_b16 a[148:149], v35 offset:256
    ds_read_b64_tr_b16 a[150:151], v35 offset:8448
    v_mfma_f32_16x16x32_bf16 v[108:111], a[188:191], a[124:127], v[108:111]
    s_waitcnt lgkmcnt(8)
    v_mfma_f32_16x16x32_bf16 v[128:131], a[128:131], v[112:115], v[128:131]
    s_mov_b32 m0, s26
    ds_read_b64_tr_b16 a[152:153], v36 offset:256
    ds_read_b64_tr_b16 a[154:155], v36 offset:8448
    v_mfma_f32_16x16x32_bf16 v[132:135], a[128:131], v[116:119], v[132:135]
    s_add_u32 s30, s23, 4096
    v_mfma_f32_16x16x32_bf16 v[136:139], a[132:135], v[112:115], v[136:139]
    s_add_u32 s25, s25, 32768
    ds_read_b64_tr_b16 a[156:157], v37 offset:256
    ds_read_b64_tr_b16 a[158:159], v37 offset:8448
    v_mfma_f32_16x16x32_bf16 v[140:143], a[132:135], v[116:119], v[140:143]
    s_waitcnt lgkmcnt(8)
    buffer_load_dwordx4 v2, s[8:11], s23 offen offset:0 nt lds
    v_mfma_f32_16x16x32_bf16 v[144:147], a[136:139], v[112:115], v[144:147]
    s_cmp_ge_u32 s25, 163840
    ds_read_b64_tr_b16 a[160:161], v30 offset:16640
    ds_read_b64_tr_b16 a[162:163], v30 offset:24832
    v_mfma_f32_16x16x32_bf16 v[148:151], a[136:139], v[116:119], v[148:151]
    s_cselect_b32 s25, 0, s25
    buffer_load_dwordx4 v3, s[8:11], s23 offen offset:1024 nt lds
    v_mfma_f32_16x16x32_bf16 v[152:155], a[140:143], v[112:115], v[152:155]
    ds_read_b64_tr_b16 a[164:165], v31 offset:16640
    ds_read_b64_tr_b16 a[166:167], v31 offset:24832
    v_mfma_f32_16x16x32_bf16 v[156:159], a[140:143], v[116:119], v[156:159]
    s_waitcnt lgkmcnt(8)
    buffer_load_dwordx4 v4, s[8:11], s23 offen offset:2048 nt lds
    v_mfma_f32_16x16x32_bf16 v[160:163], a[144:147], v[112:115], v[160:163]
    ds_read_b64_tr_b16 a[168:169], v32 offset:16640
    ds_read_b64_tr_b16 a[170:171], v32 offset:24832
    v_mfma_f32_16x16x32_bf16 v[164:167], a[144:147], v[116:119], v[164:167]
    buffer_load_dwordx4 v5, s[8:11], s23 offen offset:3072 nt lds
    v_mfma_f32_16x16x32_bf16 v[168:171], a[148:151], v[112:115], v[168:171]
    s_add_u32 m0, s26, 4096
    ds_read_b64_tr_b16 a[172:173], v33 offset:16640
    ds_read_b64_tr_b16 a[174:175], v33 offset:24832
    v_mfma_f32_16x16x32_bf16 v[172:175], a[148:151], v[116:119], v[172:175]
    s_waitcnt lgkmcnt(8)
    v_max3_f32 v42, v80, v81, v82
    v_max3_f32 v43, v84, v85, v86
    v_mfma_f32_16x16x32_bf16 v[176:179], a[152:155], v[112:115], v[176:179]
    s_add_u32 s23, s23, 32768
    ds_read_b64_tr_b16 a[176:177], v34 offset:16640
    ds_read_b64_tr_b16 a[178:179], v34 offset:24832
    v_mfma_f32_16x16x32_bf16 v[180:183], a[152:155], v[116:119], v[180:183]
    buffer_load_dwordx4 v6, s[8:11], s30 offen offset:0 nt lds
    v_mfma_f32_16x16x32_bf16 v[184:187], a[156:159], v[112:115], v[184:187]
    ds_read_b64_tr_b16 a[180:181], v35 offset:16640
    ds_read_b64_tr_b16 a[182:183], v35 offset:24832
    buffer_load_dwordx4 v7, s[8:11], s30 offen offset:1024 nt lds
    v_mfma_f32_16x16x32_bf16 v[188:191], a[156:159], v[116:119], v[188:191]
    s_waitcnt lgkmcnt(8)
    buffer_load_dwordx4 v8, s[8:11], s30 offen offset:2048 nt lds
    v_mfma_f32_16x16x32_bf16 v[128:131], a[160:163], v[120:123], v[128:131]
    ds_read_b64_tr_b16 a[184:185], v36 offset:16640
    ds_read_b64_tr_b16 a[186:187], v36 offset:24832
    v_mfma_f32_16x16x32_bf16 v[132:135], a[160:163], v[124:127], v[132:135]
    buffer_load_dwordx4 v9, s[8:11], s30 offen offset:3072 nt lds
    v_mfma_f32_16x16x32_bf16 v[136:139], a[164:167], v[120:123], v[136:139]
    ds_read_b64_tr_b16 a[188:189], v37 offset:16640
    ds_read_b64_tr_b16 a[190:191], v37 offset:24832
    v_mfma_f32_16x16x32_bf16 v[140:143], a[164:167], v[124:127], v[140:143]
    s_waitcnt lgkmcnt(8)
    v_max3_f32 v42, v83, v88, v42
    v_max3_f32 v43, v87, v92, v43
    v_mfma_f32_16x16x32_bf16 v[144:147], a[168:171], v[120:123], v[144:147]
    v_max3_f32 v42, v89, v90, v42
    v_max3_f32 v43, v93, v94, v43
    v_mfma_f32_16x16x32_bf16 v[148:151], a[168:171], v[124:127], v[148:151]
    v_max3_f32 v42, v91, v96, v42
    v_max3_f32 v43, v95, v100, v43
    v_mfma_f32_16x16x32_bf16 v[152:155], a[172:175], v[120:123], v[152:155]
    v_max3_f32 v42, v97, v98, v42
    v_max3_f32 v43, v101, v102, v43
    v_mfma_f32_16x16x32_bf16 v[156:159], a[172:175], v[124:127], v[156:159]
    s_waitcnt lgkmcnt(4)
    v_max3_f32 v42, v99, v104, v42
    v_max3_f32 v43, v103, v108, v43
    v_mfma_f32_16x16x32_bf16 v[160:163], a[176:179], v[120:123], v[160:163]
    ds_read_b64_tr_b16 a[128:129], v30 offset:0
    ds_read_b64_tr_b16 a[130:131], v30 offset:8192
    v_mfma_f32_16x16x32_bf16 v[164:167], a[176:179], v[124:127], v[164:167]
    v_max3_f32 v42, v105, v106, v42
    v_max3_f32 v43, v109, v110, v43
    v_mfma_f32_16x16x32_bf16 v[168:171], a[180:183], v[120:123], v[168:171]
    ds_read_b64_tr_b16 a[132:133], v31 offset:0
    ds_read_b64_tr_b16 a[134:135], v31 offset:8192
    v_mfma_f32_16x16x32_bf16 v[172:175], a[180:183], v[124:127], v[172:175]
    s_waitcnt lgkmcnt(4)
    v_max_f32 v42, v107, v42
    v_max_f32 v43, v111, v43
    v_mfma_f32_16x16x32_bf16 v[176:179], a[184:187], v[120:123], v[176:179]
    ds_read_b64_tr_b16 a[136:137], v32 offset:0
    ds_read_b64_tr_b16 a[138:139], v32 offset:8192
    v_mfma_f32_16x16x32_bf16 v[180:183], a[184:187], v[124:127], v[180:183]
    v_max_f32 v44, v42, v43
    v_add_u32 v18, s25, v14
    v_mfma_f32_16x16x32_bf16 v[184:187], a[188:191], v[120:123], v[184:187]
    ds_read_b64_tr_b16 a[140:141], v33 offset:0
    ds_read_b64_tr_b16 a[142:143], v33 offset:8192
    v_mfma_f32_16x16x32_bf16 v[188:191], a[188:191], v[124:127], v[188:191]
    v_cmp_lt_f32 vcc, s22, v44
    v_add_u32 v19, s25, v15
    v_mfma_f32_16x16x32_bf16 a[196:199], a[192:195], v[112:115], a[196:199]
    s_cbranch_vccnz L_rare_2
L_back_2:
    ds_read_b64_tr_b16 a[144:145], v34 offset:0
    ds_read_b64_tr_b16 a[146:147], v34 offset:8192
    v_mfma_f32_16x16x32_bf16 a[200:203], a[192:195], v[116:119], a[200:203]
    s_add_u32 s26, s26, 32768
    v_exp_f32 v80, v80
    v_mfma_f32_16x16x32_bf16 a[196:199], a[192:195], v[120:123], a[196:199]
    s_cmp_ge_u32 s26, 163840
    ds_read_b64_tr_b16 a[148:149], v35 offset:0
    ds_read_b64_tr_b16 a[150:151], v35 offset:8192
    v_mfma_f32_16x16x32_bf16 a[200:203], a[192:195], v[124:127], a[200:203]
    s_waitcnt lgkmcnt(8)
    v_exp_f32 v81, v81
    v_mfma_f32_16x16x32_bf16 a[0:3], a[128:131], v[112:115], a[0:3]
    s_cselect_b32 s26, s34, s26
    ds_read_b64_tr_b16 a[152:153], v36 offset:0
    ds_read_b64_tr_b16 a[154:155], v36 offset:8192
    v_mfma_f32_16x16x32_bf16 a[4:7], a[128:131], v[116:119], a[4:7]
    v_exp_f32 v82, v82
    v_mfma_f32_16x16x32_bf16 a[8:11], a[132:135], v[112:115], a[8:11]
    ds_read_b64_tr_b16 a[156:157], v37 offset:0
    ds_read_b64_tr_b16 a[158:159], v37 offset:8192
    v_mfma_f32_16x16x32_bf16 a[12:15], a[132:135], v[116:119], a[12:15]
    s_waitcnt lgkmcnt(8)
    v_exp_f32 v83, v83
    v_mfma_f32_16x16x32_bf16 a[16:19], a[136:139], v[112:115], a[16:19]
    ds_read_b64_tr_b16 a[160:161], v30 offset:16384
    ds_read_b64_tr_b16 a[162:163], v30 offset:24576
    v_mfma_f32_16x16x32_bf16 a[20:23], a[136:139], v[116:119], a[20:23]
    v_exp_f32 v84, v84
    v_mfma_f32_16x16x32_bf16 a[24:27], a[140:143], v[112:115], a[24:27]
    ds_read_b64_tr_b16 a[164:165], v31 offset:16384
    ds_read_b64_tr_b16 a[166:167], v31 offset:24576
    v_mfma_f32_16x16x32_bf16 a[28:31], a[140:143], v[116:119], a[28:31]
    s_waitcnt lgkmcnt(8)
    v_exp_f32 v85, v85
    v_mfma_f32_16x16x32_bf16 a[32:35], a[144:147], v[112:115], a[32:35]
    ds_read_b64_tr_b16 a[168:169], v32 offset:16384
    ds_read_b64_tr_b16 a[170:171], v32 offset:24576
    v_mfma_f32_16x16x32_bf16 a[36:39], a[144:147], v[116:119], a[36:39]
    v_exp_f32 v86, v86
    v_mfma_f32_16x16x32_bf16 a[40:43], a[148:151], v[112:115], a[40:43]
    ds_read_b64_tr_b16 a[172:173], v33 offset:16384
    ds_read_b64_tr_b16 a[174:175], v33 offset:24576
    v_mfma_f32_16x16x32_bf16 a[44:47], a[148:151], v[116:119], a[44:47]
    s_waitcnt lgkmcnt(8)
    v_exp_f32 v87, v87
    v_add_u32 v20, s25, v16
    v_mfma_f32_16x16x32_bf16 a[48:51], a[152:155], v[112:115], a[48:51]
    ds_read_b64_tr_b16 a[176:177], v34 offset:16384
    ds_read_b64_tr_b16 a[178:179], v34 offset:24576
    v_mfma_f32_16x16x32_bf16 a[52:55], a[152:155], v[116:119], a[52:55]
    v_exp_f32 v88, v88
    v_mfma_f32_16x16x32_bf16 a[56:59], a[156:159], v[112:115], a[56:59]
    ds_read_b64_tr_b16 a[180:181], v35 offset:16384
    ds_read_b64_tr_b16 a[182:183], v35 offset:24576
    v_mfma_f32_16x16x32_bf16 a[60:63], a[156:159], v[116:119], a[60:63]
    s_waitcnt lgkmcnt(8)
    v_exp_f32 v89, v89
    v_mfma_f32_16x16x32_bf16 a[0:3], a[160:163], v[120:123], a[0:3]
    ds_read_b64_tr_b16 a[184:185], v36 offset:16384
    ds_read_b64_tr_b16 a[186:187], v36 offset:24576
    v_add_u32 v21, s25, v17
    v_mfma_f32_16x16x32_bf16 a[4:7], a[160:163], v[124:127], a[4:7]
    v_exp_f32 v90, v90
    v_mfma_f32_16x16x32_bf16 a[8:11], a[164:167], v[120:123], a[8:11]
    ds_read_b64_tr_b16 a[188:189], v37 offset:16384
    ds_read_b64_tr_b16 a[190:191], v37 offset:24576
    v_mfma_f32_16x16x32_bf16 a[12:15], a[164:167], v[124:127], a[12:15]
    s_waitcnt lgkmcnt(8)
    v_exp_f32 v91, v91
    v_mfma_f32_16x16x32_bf16 a[16:19], a[168:171], v[120:123], a[16:19]
    s_waitcnt vmcnt(16)
    s_barrier
    ds_read_b128 a[128:131], v18 offset:0
    v_cvt_pk_bf16_f32 v192, v80, v81
    v_mfma_f32_16x16x32_bf16 a[20:23], a[168:171], v[124:127], a[20:23]
    v_exp_f32 v92, v92
    v_mfma_f32_16x16x32_bf16 a[24:27], a[172:175], v[120:123], a[24:27]
    ds_read_b128 a[132:135], v18 offset:8192
    v_cvt_pk_bf16_f32 v193, v82, v83
    v_mfma_f32_16x16x32_bf16 a[28:31], a[172:175], v[124:127], a[28:31]
    s_waitcnt lgkmcnt(6)
    v_exp_f32 v93, v93
    v_mfma_f32_16x16x32_bf16 a[32:35], a[176:179], v[120:123], a[32:35]
    ds_read_b128 a[136:139], v18 offset:16384
    v_cvt_pk_bf16_f32 v196, v84, v85
    v_mfma_f32_16x16x32_bf16 a[36:39], a[176:179], v[124:127], a[36:39]
    v_exp_f32 v94, v94
    v_mfma_f32_16x16x32_bf16 a[40:43], a[180:183], v[120:123], a[40:43]
    ds_read_b128 a[140:143], v18 offset:24576
    v_cvt_pk_bf16_f32 v197, v86, v87
    v_mfma_f32_16x16x32_bf16 a[44:47], a[180:183], v[124:127], a[44:47]
    s_waitcnt lgkmcnt(4)
    v_exp_f32 v95, v95
    v_mfma_f32_16x16x32_bf16 a[48:51], a[184:187], v[120:123], a[48:51]
    ds_read_b128 a[144:147], v19 offset:0
    v_cvt_pk_bf16_f32 v194, v88, v89
    v_mfma_f32_16x16x32_bf16 a[52:55], a[184:187], v[124:127], a[52:55]
    v_exp_f32 v96, v96
    v_mfma_f32_16x16x32_bf16 a[56:59], a[188:191], v[120:123], a[56:59]
    ds_read_b128 a[148:151], v19 offset:8192
    v_cvt_pk_bf16_f32 v195, v90, v91
    v_mfma_f32_16x16x32_bf16 a[60:63], a[188:191], v[124:127], a[60:63]
    s_waitcnt lgkmcnt(4)
    v_exp_f32 v97, v97
    v_mfma_f32_16x16x32_bf16 v[48:51], a[128:131], a[64:67], v[244:247]
    s_mov_b32 m0, s26
    ds_read_b128 a[152:155], v19 offset:16384
    v_cvt_pk_bf16_f32 v198, v92, v93
    v_mfma_f32_16x16x32_bf16 v[52:55], a[128:131], a[68:71], v[248:251]
    s_add_u32 s30, s24, 4096
    v_exp_f32 v98, v98
    v_mfma_f32_16x16x32_bf16 v[56:59], a[132:135], a[64:67], v[244:247]
    s_add_u32 s25, s25, 32768
    ds_read_b128 a[156:159], v19 offset:24576
    v_cvt_pk_bf16_f32 v199, v94, v95
    v_mfma_f32_16x16x32_bf16 v[60:63], a[132:135], a[68:71], v[248:251]
    s_waitcnt lgkmcnt(4)
    buffer_load_dwordx4 v10, s[12:15], s24 offen offset:0 nt lds
    v_mfma_f32_16x16x32_bf16 v[64:67], a[136:139], a[64:67], v[244:247]
    s_cmp_ge_u32 s25, 163840
    ds_read_b128 a[160:163], v20 offset:0
    v_cvt_pk_bf16_f32 v200, v96, v97
    buffer_load_dwordx4 v11, s[12:15], s24 offen offset:1024 nt lds
    v_mfma_f32_16x16x32_bf16 v[68:71], a[136:139], a[68:71], v[248:251]
    s_cselect_b32 s25, 0, s25
    buffer_load_dwordx4 v12, s[12:15], s24 offen offset:2048 nt lds
    v_mfma_f32_16x16x32_bf16 v[72:75], a[140:143], a[64:67], v[244:247]
    ds_read_b128 a[164:167], v20 offset:8192
    v_mfma_f32_16x16x32_bf16 v[76:79], a[140:143], a[68:71], v[248:251]
    s_waitcnt lgkmcnt(4)
    buffer_load_dwordx4 v13, s[12:15], s24 offen offset:3072 nt lds
    v_mfma_f32_16x16x32_bf16 v[48:51], a[144:147], a[72:75], v[48:51]
    s_add_u32 m0, s26, 4096
    ds_read_b128 a[168:171], v20 offset:16384
    v_mfma_f32_16x16x32_bf16 v[52:55], a[144:147], a[76:79], v[52:55]
    s_add_u32 s24, s24, 32768
    v_add_u32 v30, s25, v22
    v_mfma_f32_16x16x32_bf16 v[56:59], a[148:151], a[72:75], v[56:59]
    ds_read_b128 a[172:175], v20 offset:24576
    buffer_load_dwordx4 v10, s[12:15], s30 offen offset:0 nt lds
    v_mfma_f32_16x16x32_bf16 v[60:63], a[148:151], a[76:79], v[60:63]
    s_waitcnt lgkmcnt(4)
    buffer_load_dwordx4 v11, s[12:15], s30 offen offset:1024 nt lds
    v_mfma_f32_16x16x32_bf16 v[64:67], a[152:155], a[72:75], v[64:67]
    ds_read_b128 a[176:179], v21 offset:0
    v_mfma_f32_16x16x32_bf16 v[68:71], a[152:155], a[76:79], v[68:71]
    buffer_load_dwordx4 v12, s[12:15], s30 offen offset:2048 nt lds
    v_mfma_f32_16x16x32_bf16 v[72:75], a[156:159], a[72:75], v[72:75]
    ds_read_b128 a[180:183], v21 offset:8192
    v_mfma_f32_16x16x32_bf16 v[76:79], a[156:159], a[76:79], v[76:79]
    s_waitcnt lgkmcnt(4)
    buffer_load_dwordx4 v13, s[12:15], s30 offen offset:3072 nt lds
    v_mfma_f32_16x16x32_bf16 v[48:51], a[160:163], a[80:83], v[48:51]
    s_add_u32 s26, s26, 32768
    ds_read_b128 a[184:187], v21 offset:16384
    v_mfma_f32_16x16x32_bf16 v[52:55], a[160:163], a[84:87], v[52:55]
    s_cmp_ge_u32 s26, 163840
    v_add_u32 v31, s25, v23
    v_mfma_f32_16x16x32_bf16 v[56:59], a[164:167], a[80:83], v[56:59]
    s_cselect_b32 s26, s34, s26
    ds_read_b128 a[188:191], v21 offset:24576
    v_mfma_f32_16x16x32_bf16 v[60:63], a[164:167], a[84:87], v[60:63]
    s_waitcnt lgkmcnt(4)
    v_add_u32 v32, s25, v24
    v_mfma_f32_16x16x32_bf16 v[64:67], a[168:171], a[80:83], v[64:67]
    ds_read_b128 a[128:131], v18 offset:256
    v_mfma_f32_16x16x32_bf16 v[68:71], a[168:171], a[84:87], v[68:71]
    v_add_u32 v33, s25, v25
    v_mfma_f32_16x16x32_bf16 v[72:75], a[172:175], a[80:83], v[72:75]
    ds_read_b128 a[132:135], v18 offset:8448
    v_mfma_f32_16x16x32_bf16 v[76:79], a[172:175], a[84:87], v[76:79]
    s_waitcnt lgkmcnt(4)
    v_add_u32 v34, s25, v26
    v_mfma_f32_16x16x32_bf16 v[48:51], a[176:179], a[88:91], v[48:51]
    ds_read_b128 a[136:139], v18 offset:16640
    v_mfma_f32_16x16x32_bf16 v[52:55], a[176:179], a[92:95], v[52:55]
    v_add_u32 v35, s25, v27
    v_mfma_f32_16x16x32_bf16 v[56:59], a[180:183], a[88:91], v[56:59]
    ds_read_b128 a[140:143], v18 offset:24832
    v_mfma_f32_16x16x32_bf16 v[60:63], a[180:183], a[92:95], v[60:63]
    s_waitcnt lgkmcnt(4)
    v_add_u32 v36, s25, v28
    v_mfma_f32_16x16x32_bf16 v[64:67], a[184:187], a[88:91], v[64:67]
    ds_read_b128 a[144:147], v19 offset:256
    v_add_u32 v37, s25, v29
    v_mfma_f32_16x16x32_bf16 v[68:71], a[184:187], a[92:95], v[68:71]
    v_exp_f32 v99, v99
    v_mfma_f32_16x16x32_bf16 v[72:75], a[188:191], a[88:91], v[72:75]
    ds_read_b128 a[148:151], v19 offset:8448
    v_cvt_pk_bf16_f32 v201, v98, v99
    v_mfma_f32_16x16x32_bf16 v[76:79], a[188:191], a[92:95], v[76:79]
    s_waitcnt lgkmcnt(4)
    v_exp_f32 v100, v100
    v_mfma_f32_16x16x32_bf16 v[48:51], a[128:131], a[96:99], v[48:51]
    ds_read_b128 a[152:155], v19 offset:16640
    v_mfma_f32_16x16x32_bf16 v[52:55], a[128:131], a[100:103], v[52:55]
    v_exp_f32 v101, v101
    v_mfma_f32_16x16x32_bf16 v[56:59], a[132:135], a[96:99], v[56:59]
    ds_read_b128 a[156:159], v19 offset:24832
    v_cvt_pk_bf16_f32 v204, v100, v101
    v_mfma_f32_16x16x32_bf16 v[60:63], a[132:135], a[100:103], v[60:63]
    s_waitcnt lgkmcnt(4)
    v_exp_f32 v102, v102
    v_mfma_f32_16x16x32_bf16 v[64:67], a[136:139], a[96:99], v[64:67]
    ds_read_b128 a[160:163], v20 offset:256
    v_mfma_f32_16x16x32_bf16 v[68:71], a[136:139], a[100:103], v[68:71]
    v_exp_f32 v103, v103
    v_mfma_f32_16x16x32_bf16 v[72:75], a[140:143], a[96:99], v[72:75]
    ds_read_b128 a[164:167], v20 offset:8448
    v_cvt_pk_bf16_f32 v205, v102, v103
    v_mfma_f32_16x16x32_bf16 v[76:79], a[140:143], a[100:103], v[76:79]
    s_waitcnt lgkmcnt(4)
    v_exp_f32 v104, v104
    v_mfma_f32_16x16x32_bf16 v[48:51], a[144:147], a[104:107], v[48:51]
    ds_read_b128 a[168:171], v20 offset:16640
    v_mfma_f32_16x16x32_bf16 v[52:55], a[144:147], a[108:111], v[52:55]
    v_exp_f32 v105, v105
    v_mfma_f32_16x16x32_bf16 v[56:59], a[148:151], a[104:107], v[56:59]
    ds_read_b128 a[172:175], v20 offset:24832
    v_cvt_pk_bf16_f32 v202, v104, v105
    v_mfma_f32_16x16x32_bf16 v[60:63], a[148:151], a[108:111], v[60:63]
    s_waitcnt lgkmcnt(4)
    v_exp_f32 v106, v106
    v_mfma_f32_16x16x32_bf16 v[64:67], a[152:155], a[104:107], v[64:67]
    ds_read_b128 a[176:179], v21 offset:256
    v_mfma_f32_16x16x32_bf16 v[68:71], a[152:155], a[108:111], v[68:71]
    v_exp_f32 v107, v107
    v_mfma_f32_16x16x32_bf16 v[72:75], a[156:159], a[104:107], v[72:75]
    ds_read_b128 a[180:183], v21 offset:8448
    v_cvt_pk_bf16_f32 v203, v106, v107
    v_mfma_f32_16x16x32_bf16 v[76:79], a[156:159], a[108:111], v[76:79]
    s_waitcnt lgkmcnt(4)
    v_exp_f32 v108, v108
    v_mfma_f32_16x16x32_bf16 v[48:51], a[160:163], a[112:115], v[48:51]
    ds_read_b128 a[184:187], v21 offset:16640
    v_mfma_f32_16x16x32_bf16 v[52:55], a[160:163], a[116:119], v[52:55]
    v_exp_f32 v109, v109
    v_mfma_f32_16x16x32_bf16 v[56:59], a[164:167], a[112:115], v[56:59]
    ds_read_b128 a[188:191], v21 offset:24832
    v_cvt_pk_bf16_f32 v206, v108, v109
    v_mfma_f32_16x16x32_bf16 v[60:63], a[164:167], a[116:119], v[60:63]
    s_waitcnt lgkmcnt(4)
    v_exp_f32 v110, v110
    v_mfma_f32_16x16x32_bf16 v[64:67], a[168:171], a[112:115], v[64:67]
    s_waitcnt vmcnt(16)
    s_barrier
    ds_read_b64_tr_b16 a[128:129], v30 offset:256
    ds_read_b64_tr_b16 a[130:131], v30 offset:8448
    v_mfma_f32_16x16x32_bf16 v[68:71], a[168:171], a[116:119], v[68:71]
    v_exp_f32 v111, v111
    v_mfma_f32_16x16x32_bf16 v[72:75], a[172:175], a[112:115], v[72:75]
    ds_read_b64_tr_b16 a[132:133], v31 offset:256
    ds_read_b64_tr_b16 a[134:135], v31 offset:8448
    v_mfma_f32_16x16x32_bf16 v[76:79], a[172:175], a[116:119], v[76:79]
    s_waitcnt lgkmcnt(6)
    v_cvt_pk_bf16_f32 v207, v110, v111
    v_mfma_f32_16x16x32_bf16 v[48:51], a[176:179], a[120:123], v[48:51]
    ds_read_b64_tr_b16 a[136:137], v32 offset:256
    ds_read_b64_tr_b16 a[138:139], v32 offset:8448
    v_mfma_f32_16x16x32_bf16 v[52:55], a[176:179], a[124:127], v[52:55]
    v_mfma_f32_16x16x32_bf16 v[56:59], a[180:183], a[120:123], v[56:59]
    ds_read_b64_tr_b16 a[140:141], v33 offset:256
    ds_read_b64_tr_b16 a[142:143], v33 offset:8448
    v_mfma_f32_16x16x32_bf16 v[60:63], a[180:183], a[124:127], v[60:63]
    s_waitcnt lgkmcnt(8)
    v_mfma_f32_16x16x32_bf16 v[64:67], a[184:187], a[120:123], v[64:67]
    ds_read_b64_tr_b16 a[144:145], v34 offset:256
    ds_read_b64_tr_b16 a[146:147], v34 offset:8448
    v_mfma_f32_16x16x32_bf16 v[68:71], a[184:187], a[124:127], v[68:71]
    v_mfma_f32_16x16x32_bf16 v[72:75], a[188:191], a[120:123], v[72:75]
    ds_read_b64_tr_b16 a[148:149], v35 offset:256
    ds_read_b64_tr_b16 a[150:151], v35 offset:8448
    v_mfma_f32_16x16x32_bf16 v[76:79], a[188:191], a[124:127], v[76:79]
    s_waitcnt lgkmcnt(8)
    v_mfma_f32_16x16x32_bf16 v[128:131], a[128:131], v[192:195], v[128:131]
    s_mov_b32 m0, s26
    ds_read_b64_tr_b16 a[152:153], v36 offset:256
    ds_read_b64_tr_b16 a[154:155], v36 offset:8448
    v_mfma_f32_16x16x32_bf16 v[132:135], a[128:131], v[196:199], v[132:135]
    s_add_u32 s30, s23, 4096
    v_mfma_f32_16x16x32_bf16 v[136:139], a[132:135], v[192:195], v[136:139]
    s_add_u32 s25, s25, 32768
    ds_read_b64_tr_b16 a[156:157], v37 offset:256
    ds_read_b64_tr_b16 a[158:159], v37 offset:8448
    v_mfma_f32_16x16x32_bf16 v[140:143], a[132:135], v[196:199], v[140:143]
    s_waitcnt lgkmcnt(8)
    buffer_load_dwordx4 v2, s[8:11], s23 offen offset:0 nt lds
    v_mfma_f32_16x16x32_bf16 v[144:147], a[136:139], v[192:195], v[144:147]
    s_cmp_ge_u32 s25, 163840
    ds_read_b64_tr_b16 a[160:161], v30 offset:16640
    ds_read_b64_tr_b16 a[162:163], v30 offset:24832
    v_mfma_f32_16x16x32_bf16 v[148:151], a[136:139], v[196:199], v[148:151]
    s_cselect_b32 s25, 0, s25
    buffer_load_dwordx4 v3, s[8:11], s23 offen offset:1024 nt lds
    v_mfma_f32_16x16x32_bf16 v[152:155], a[140:143], v[192:195], v[152:155]
    ds_read_b64_tr_b16 a[164:165], v31 offset:16640
    ds_read_b64_tr_b16 a[166:167], v31 offset:24832
    v_mfma_f32_16x16x32_bf16 v[156:159], a[140:143], v[196:199], v[156:159]
    s_waitcnt lgkmcnt(8)
    v_max3_f32 v42, v48, v49, v50
    v_max3_f32 v43, v52, v53, v54
    v_mfma_f32_16x16x32_bf16 v[160:163], a[144:147], v[192:195], v[160:163]
    ds_read_b64_tr_b16 a[168:169], v32 offset:16640
    ds_read_b64_tr_b16 a[170:171], v32 offset:24832
    v_mfma_f32_16x16x32_bf16 v[164:167], a[144:147], v[196:199], v[164:167]
    buffer_load_dwordx4 v4, s[8:11], s23 offen offset:2048 nt lds
    v_mfma_f32_16x16x32_bf16 v[168:171], a[148:151], v[192:195], v[168:171]
    ds_read_b64_tr_b16 a[172:173], v33 offset:16640
    ds_read_b64_tr_b16 a[174:175], v33 offset:24832
    v_mfma_f32_16x16x32_bf16 v[172:175], a[148:151], v[196:199], v[172:175]
    s_waitcnt lgkmcnt(8)
    buffer_load_dwordx4 v5, s[8:11], s23 offen offset:3072 nt lds
    v_mfma_f32_16x16x32_bf16 v[176:179], a[152:155], v[192:195], v[176:179]
    s_add_u32 m0, s26, 4096
    ds_read_b64_tr_b16 a[176:177], v34 offset:16640
    ds_read_b64_tr_b16 a[178:179], v34 offset:24832
    v_mfma_f32_16x16x32_bf16 v[180:183], a[152:155], v[196:199], v[180:183]
    s_add_u32 s23, s23, 32768
    v_max3_f32 v42, v51, v56, v42
    v_max3_f32 v43, v55, v60, v43
    v_mfma_f32_16x16x32_bf16 v[184:187], a[156:159], v[192:195], v[184:187]
    ds_read_b64_tr_b16 a[180:181], v35 offset:16640
    ds_read_b64_tr_b16 a[182:183], v35 offset:24832
    v_mfma_f32_16x16x32_bf16 v[188:191], a[156:159], v[196:199], v[188:191]
    s_waitcnt lgkmcnt(8)
    buffer_load_dwordx4 v6, s[8:11], s30 offen offset:0 nt lds
    v_max3_f32 v42, v57, v58, v42
    v_mfma_f32_16x16x32_bf16 v[128:131], a[160:163], v[200:203], v[128:131]
    ds_read_b64_tr_b16 a[184:185], v36 offset:16640
    ds_read_b64_tr_b16 a[186:187], v36 offset:24832
    v_mfma_f32_16x16x32_bf16 v[132:135], a[160:163], v[204:207], v[132:135]
    buffer_load_dwordx4 v7, s[8:11], s30 offen offset:1024 nt lds
    v_mfma_f32_16x16x32_bf16 v[136:139], a[164:167], v[200:203], v[136:139]
    ds_read_b64_tr_b16 a[188:189], v37 offset:16640
    ds_read_b64_tr_b16 a[190:191], v37 offset:24832
    v_mfma_f32_16x16x32_bf16 v[140:143], a[164:167], v[204:207], v[140:143]
    s_waitcnt lgkmcnt(8)
    v_max3_f32 v43, v61, v62, v43
    v_max3_f32 v42, v59, v64, v42
    v_mfma_f32_16x16x32_bf16 v[144:147], a[168:171], v[200:203], v[144:147]
    v_max3_f32 v43, v63, v68, v43
    v_max3_f32 v42, v65, v66, v42
    v_mfma_f32_16x16x32_bf16 v[148:151], a[168:171], v[204:207], v[148:151]
    buffer_load_dwordx4 v8, s[8:11], s30 offen offset:2048 nt lds
    v_mfma_f32_16x16x32_bf16 v[152:155], a[172:175], v[200:203], v[152:155]
    v_max3_f32 v43, v69, v70, v43
    v_max3_f32 v42, v67, v72, v42
    v_mfma_f32_16x16x32_bf16 v[156:159], a[172:175], v[204:207], v[156:159]
    s_waitcnt lgkmcnt(4)
    v_max3_f32 v43, v71, v76, v43
    v_max3_f32 v42, v73, v74, v42
    v_mfma_f32_16x16x32_bf16 v[160:163], a[176:179], v[200:203], v[160:163]
    ds_read_b64_tr_b16 a[128:129], v30 offset:0
    ds_read_b64_tr_b16 a[130:131], v30 offset:8192
    v_mfma_f32_16x16x32_bf16 v[164:167], a[176:179], v[204:207], v[164:167]
    buffer_load_dwordx4 v9, s[8:11], s30 offen offset:3072 nt lds
    v_mfma_f32_16x16x32_bf16 v[168:171], a[180:183], v[200:203], v[168:171]
    ds_read_b64_tr_b16 a[132:133], v31 offset:0
    ds_read_b64_tr_b16 a[134:135], v31 offset:8192
    v_mfma_f32_16x16x32_bf16 v[172:175], a[180:183], v[204:207], v[172:175]
    s_waitcnt lgkmcnt(4)
    v_max3_f32 v43, v77, v78, v43
    v_max_f32 v42, v75, v42
    v_mfma_f32_16x16x32_bf16 v[176:179], a[184:187], v[200:203], v[176:179]
    ds_read_b64_tr_b16 a[136:137], v32 offset:0
    ds_read_b64_tr_b16 a[138:139], v32 offset:8192
    v_mfma_f32_16x16x32_bf16 v[180:183], a[184:187], v[204:207], v[180:183]
    v_max_f32 v43, v79, v43
    v_add_u32 v18, s25, v14
    v_mfma_f32_16x16x32_bf16 v[184:187], a[188:191], v[200:203], v[184:187]
    ds_read_b64_tr_b16 a[140:141], v33 offset:0
    ds_read_b64_tr_b16 a[142:143], v33 offset:8192
    v_mfma_f32_16x16x32_bf16 v[188:191], a[188:191], v[204:207], v[188:191]
    v_max_f32 v44, v42, v43
    v_add_u32 v19, s25, v15
    v_add_u32 v20, s25, v16
    v_mfma_f32_16x16x32_bf16 a[196:199], a[192:195], v[192:195], a[196:199]
    ds_read_b64_tr_b16 a[144:145], v34 offset:0
    ds_read_b64_tr_b16 a[146:147], v34 offset:8192
    v_mfma_f32_16x16x32_bf16 a[200:203], a[192:195], v[196:199], a[200:203]
    v_cmp_lt_f32 vcc, s22, v44
    v_add_u32 v21, s25, v17
    v_mfma_f32_16x16x32_bf16 a[196:199], a[192:195], v[200:203], a[196:199]
    s_cbranch_vccnz L_rare_3
L_back_3:
    ds_read_b64_tr_b16 a[148:149], v35 offset:0
    ds_read_b64_tr_b16 a[150:151], v35 offset:8192
    v_mfma_f32_16x16x32_bf16 a[200:203], a[192:195], v[204:207], a[200:203]
    s_waitcnt lgkmcnt(8)
    v_exp_f32 v48, v48
    v_mfma_f32_16x16x32_bf16 a[0:3], a[128:131], v[192:195], a[0:3]
    s_add_u32 s26, s26, 32768
    ds_read_b64_tr_b16 a[152:153], v36 offset:0
    ds_read_b64_tr_b16 a[154:155], v36 offset:8192
    v_mfma_f32_16x16x32_bf16 a[4:7], a[128:131], v[196:199], a[4:7]
    s_cmp_ge_u32 s26, 163840
    v_exp_f32 v49, v49
    v_mfma_f32_16x16x32_bf16 a[8:11], a[132:135], v[192:195], a[8:11]
    s_cselect_b32 s26, s34, s26
    ds_read_b64_tr_b16 a[156:157], v37 offset:0
    ds_read_b64_tr_b16 a[158:159], v37 offset:8192
    v_mfma_f32_16x16x32_bf16 a[12:15], a[132:135], v[196:199], a[12:15]
    s_waitcnt lgkmcnt(8)
    v_exp_f32 v50, v50
    v_mfma_f32_16x16x32_bf16 a[16:19], a[136:139], v[192:195], a[16:19]
    ds_read_b64_tr_b16 a[160:161], v30 offset:16384
    ds_read_b64_tr_b16 a[162:163], v30 offset:24576
    v_mfma_f32_16x16x32_bf16 a[20:23], a[136:139], v[196:199], a[20:23]
    v_exp_f32 v51, v51
    v_mfma_f32_16x16x32_bf16 a[24:27], a[140:143], v[192:195], a[24:27]
    ds_read_b64_tr_b16 a[164:165], v31 offset:16384
    ds_read_b64_tr_b16 a[166:167], v31 offset:24576
    v_mfma_f32_16x16x32_bf16 a[28:31], a[140:143], v[196:199], a[28:31]
    s_waitcnt lgkmcnt(8)
    v_exp_f32 v52, v52
    v_mfma_f32_16x16x32_bf16 a[32:35], a[144:147], v[192:195], a[32:35]
    ds_read_b64_tr_b16 a[168:169], v32 offset:16384
    ds_read_b64_tr_b16 a[170:171], v32 offset:24576
    v_mfma_f32_16x16x32_bf16 a[36:39], a[144:147], v[196:199], a[36:39]
    v_exp_f32 v53, v53
    v_mfma_f32_16x16x32_bf16 a[40:43], a[148:151], v[192:195], a[40:43]
    ds_read_b64_tr_b16 a[172:173], v33 offset:16384
    ds_read_b64_tr_b16 a[174:175], v33 offset:24576
    v_mfma_f32_16x16x32_bf16 a[44:47], a[148:151], v[196:199], a[44:47]
    s_waitcnt lgkmcnt(8)
    v_exp_f32 v54, v54
    v_cvt_pk_bf16_f32 v112, v48, v49
    v_mfma_f32_16x16x32_bf16 a[48:51], a[152:155], v[192:195], a[48:51]
    ds_read_b64_tr_b16 a[176:177], v34 offset:16384
    ds_read_b64_tr_b16 a[178:179], v34 offset:24576
    v_mfma_f32_16x16x32_bf16 a[52:55], a[152:155], v[196:199], a[52:55]
    v_exp_f32 v55, v55
    v_mfma_f32_16x16x32_bf16 a[56:59], a[156:159], v[192:195], a[56:59]
    ds_read_b64_tr_b16 a[180:181], v35 offset:16384
    ds_read_b64_tr_b16 a[182:183], v35 offset:24576
    v_mfma_f32_16x16x32_bf16 a[60:63], a[156:159], v[196:199], a[60:63]
    s_waitcnt lgkmcnt(8)
    v_exp_f32 v56, v56
    v_mfma_f32_16x16x32_bf16 a[0:3], a[160:163], v[200:203], a[0:3]
    ds_read_b64_tr_b16 a[184:185], v36 offset:16384
    ds_read_b64_tr_b16 a[186:187], v36 offset:24576
    v_mfma_f32_16x16x32_bf16 a[4:7], a[160:163], v[204:207], a[4:7]
    v_exp_f32 v57, v57
    v_mfma_f32_16x16x32_bf16 a[8:11], a[164:167], v[200:203], a[8:11]
    ds_read_b64_tr_b16 a[188:189], v37 offset:16384
    ds_read_b64_tr_b16 a[190:191], v37 offset:24576
    v_mfma_f32_16x16x32_bf16 a[12:15], a[164:167], v[204:207], a[12:15]
    s_waitcnt lgkmcnt(8)
    v_exp_f32 v58, v58
    v_mfma_f32_16x16x32_bf16 a[16:19], a[168:171], v[200:203], a[16:19]
    s_waitcnt vmcnt(16)
    s_barrier
    ds_read_b128 a[128:131], v18 offset:0
    v_cvt_pk_bf16_f32 v113, v50, v51
    v_mfma_f32_16x16x32_bf16 a[20:23], a[168:171], v[204:207], a[20:23]
    v_exp_f32 v59, v59
    v_mfma_f32_16x16x32_bf16 a[24:27], a[172:175], v[200:203], a[24:27]
    ds_read_b128 a[132:135], v18 offset:8192
    v_cvt_pk_bf16_f32 v116, v52, v53
    v_mfma_f32_16x16x32_bf16 a[28:31], a[172:175], v[204:207], a[28:31]
    s_waitcnt lgkmcnt(6)
    v_exp_f32 v60, v60
    v_mfma_f32_16x16x32_bf16 a[32:35], a[176:179], v[200:203], a[32:35]
    ds_read_b128 a[136:139], v18 offset:16384
    v_cvt_pk_bf16_f32 v117, v54, v55
    v_mfma_f32_16x16x32_bf16 a[36:39], a[176:179], v[204:207], a[36:39]
    v_exp_f32 v61, v61
    v_mfma_f32_16x16x32_bf16 a[40:43], a[180:183], v[200:203], a[40:43]
    ds_read_b128 a[140:143], v18 offset:24576
    v_cvt_pk_bf16_f32 v114, v56, v57
    v_mfma_f32_16x16x32_bf16 a[44:47], a[180:183], v[204:207], a[44:47]
    s_waitcnt lgkmcnt(4)
    v_exp_f32 v62, v62
    v_cvt_pk_bf16_f32 v115, v58, v59
    v_mfma_f32_16x16x32_bf16 a[48:51], a[184:187], v[200:203], a[48:51]
    ds_read_b128 a[144:147], v19 offset:0
    v_cvt_pk_bf16_f32 v118, v60, v61
    v_mfma_f32_16x16x32_bf16 a[52:55], a[184:187], v[204:207], a[52:55]
    v_exp_f32 v63, v63
    v_mfma_f32_16x16x32_bf16 a[56:59], a[188:191], v[200:203], a[56:59]
    ds_read_b128 a[148:151], v19 offset:8192
    v_cvt_pk_bf16_f32 v119, v62, v63
    v_mfma_f32_16x16x32_bf16 a[60:63], a[188:191], v[204:207], a[60:63]
    s_waitcnt lgkmcnt(4)
    v_exp_f32 v64, v64
    v_mfma_f32_16x16x32_bf16 v[80:83], a[128:131], a[64:67], v[244:247]
    s_mov_b32 m0, s26
    ds_read_b128 a[152:155], v19 offset:16384
    v_mfma_f32_16x16x32_bf16 v[84:87], a[128:131], a[68:71], v[248:251]
    s_add_u32 s30, s24, 4096
    v_exp_f32 v65, v65
    v_mfma_f32_16x16x32_bf16 v[88:91], a[132:135], a[64:67], v[244:247]
    s_add_u32 s25, s25, 32768
    ds_read_b128 a[156:159], v19 offset:24576
    v_cvt_pk_bf16_f32 v120, v64, v65
    v_mfma_f32_16x16x32_bf16 v[92:95], a[132:135], a[68:71], v[248:251]
    s_waitcnt lgkmcnt(4)
    buffer_load_dwordx4 v10, s[12:15], s24 offen offset:0 nt lds
    v_mfma_f32_16x16x32_bf16 v[96:99], a[136:139], a[64:67], v[244:247]
    s_cmp_ge_u32 s25, 163840
    ds_read_b128 a[160:163], v20 offset:0
    v_mfma_f32_16x16x32_bf16 v[100:103], a[136:139], a[68:71], v[248:251]
    s_cselect_b32 s25, 0, s25
    buffer_load_dwordx4 v11, s[12:15], s24 offen offset:1024 nt lds
    v_mfma_f32_16x16x32_bf16 v[104:107], a[140:143], a[64:67], v[244:247]
    ds_read_b128 a[164:167], v20 offset:8192
    v_add_u32 v30, s25, v22
    v_mfma_f32_16x16x32_bf16 v[108:111], a[140:143], a[68:71], v[248:251]
    s_waitcnt lgkmcnt(4)
    buffer_load_dwordx4 v12, s[12:15], s24 offen offset:2048 nt lds
    v_mfma_f32_16x16x32_bf16 v[80:83], a[144:147], a[72:75], v[80:83]
    ds_read_b128 a[168:171], v20 offset:16384
    v_add_u32 v31, s25, v23
    v_mfma_f32_16x16x32_bf16 v[84:87], a[144:147], a[76:79], v[84:87]
    v_exp_f32 v66, v66
    v_mfma_f32_16x16x32_bf16 v[88:91], a[148:151], a[72:75], v[88:91]
    ds_read_b128 a[172:175], v20 offset:24576
    v_add_u32 v32, s25, v24
    v_mfma_f32_16x16x32_bf16 v[92:95], a[148:151], a[76:79], v[92:95]
    s_waitcnt lgkmcnt(4)
    buffer_load_dwordx4 v13, s[12:15], s24 offen offset:3072 nt lds
    v_add_u32 v33, s25, v25
    v_mfma_f32_16x16x32_bf16 v[96:99], a[152:155], a[72:75], v[96:99]
    s_add_u32 m0, s26, 4096
    ds_read_b128 a[176:179], v21 offset:0
    v_add_u32 v34, s25, v26
    v_mfma_f32_16x16x32_bf16 v[100:103], a[152:155], a[76:79], v[100:103]
    s_add_u32 s24, s24, 32768
    v_exp_f32 v67, v67
    v_mfma_f32_16x16x32_bf16 v[104:107], a[156:159], a[72:75], v[104:107]
    ds_read_b128 a[180:183], v21 offset:8192
    v_add_u32 v35, s25, v27
    buffer_load_dwordx4 v10, s[12:15], s30 offen offset:0 nt lds
    v_mfma_f32_16x16x32_bf16 v[108:111], a[156:159], a[76:79], v[108:111]
    s_waitcnt lgkmcnt(4)
    v_add_u32 v36, s25, v28
    v_mfma_f32_16x16x32_bf16 v[80:83], a[160:163], a[80:83], v[80:83]
    ds_read_b128 a[184:187], v21 offset:16384
    v_mfma_f32_16x16x32_bf16 v[84:87], a[160:163], a[84:87], v[84:87]
    buffer_load_dwordx4 v11, s[12:15], s30 offen offset:1024 nt lds
    v_mfma_f32_16x16x32_bf16 v[88:91], a[164:167], a[80:83], v[88:91]
    ds_read_b128 a[188:191], v21 offset:24576
    v_mfma_f32_16x16x32_bf16 v[92:95], a[164:167], a[84:87], v[92:95]
    s_waitcnt lgkmcnt(4)
    buffer_load_dwordx4 v12, s[12:15], s30 offen offset:2048 nt lds
    v_mfma_f32_16x16x32_bf16 v[96:99], a[168:171], a[80:83], v[96:99]
    ds_read_b128 a[128:131], v18 offset:256
    v_mfma_f32_16x16x32_bf16 v[100:103], a[168:171], a[84:87], v[100:103]
    v_add_u32 v37, s25, v29
    v_mfma_f32_16x16x32_bf16 v[104:107], a[172:175], a[80:83], v[104:107]
    ds_read_b128 a[132:135], v18 offset:8448
    v_mfma_f32_16x16x32_bf16 v[108:111], a[172:175], a[84:87], v[108:111]
    s_waitcnt lgkmcnt(4)
    buffer_load_dwordx4 v13, s[12:15], s30 offen offset:3072 nt lds
    v_mfma_f32_16x16x32_bf16 v[80:83], a[176:179], a[88:91], v[80:83]
    s_add_u32 s26, s26, 32768
    ds_read_b128 a[136:139], v18 offset:16640
    v_mfma_f32_16x16x32_bf16 v[84:87], a[176:179], a[92:95], v[84:87]
    s_cmp_ge_u32 s26, 163840
    v_cvt_pk_bf16_f32 v121, v66, v67
    v_mfma_f32_16x16x32_bf16 v[88:91], a[180:183], a[88:91], v[88:91]
    s_cselect_b32 s26, s34, s26
    ds_read_b128 a[140:143], v18 offset:24832
    v_mfma_f32_16x16x32_bf16 v[92:95], a[180:183], a[92:95], v[92:95]
    s_waitcnt lgkmcnt(4)
    v_mfma_f32_16x16x32_bf16 v[96:99], a[184:187], a[88:91], v[96:99]
    ds_read_b128 a[144:147], v19 offset:256
    v_mfma_f32_16x16x32_bf16 v[100:103], a[184:187], a[92:95], v[100:103]
    v_exp_f32 v68, v68
    v_mfma_f32_16x16x32_bf16 v[104:107], a[188:191], a[88:91], v[104:107]
    ds_read_b128 a[148:151], v19 offset:8448
    v_mfma_f32_16x16x32_bf16 v[108:111], a[188:191], a[92:95], v[108:111]
    s_waitcnt lgkmcnt(4)
    v_exp_f32 v69, v69
    v_mfma_f32_16x16x32_bf16 v[80:83], a[128:131], a[96:99], v[80:83]
    ds_read_b128 a[152:155], v19 offset:16640
    v_cvt_pk_bf16_f32 v124, v68, v69
    v_mfma_f32_16x16x32_bf16 v[84:87], a[128:131], a[100:103], v[84:87]
    v_exp_f32 v70, v70
    v_mfma_f32_16x16x32_bf16 v[88:91], a[132:135], a[96:99], v[88:91]
    ds_read_b128 a[156:159], v19 offset:24832
    v_mfma_f32_16x16x32_bf16 v[92:95], a[132:135], a[100:103], v[92:95]
    s_waitcnt lgkmcnt(4)
    v_exp_f32 v71, v71
    v_mfma_f32_16x16x32_bf16 v[96:99], a[136:139], a[96:99], v[96:99]
    ds_read_b128 a[160:163], v20 offset:256
    v_cvt_pk_bf16_f32 v125, v70, v71
    v_mfma_f32_16x16x32_bf16 v[100:103], a[136:139], a[100:103], v[100:103]
    v_exp_f32 v72, v72
    v_mfma_f32_16x16x32_bf16 v[104:107], a[140:143], a[96:99], v[104:107]
    ds_read_b128 a[164:167], v20 offset:8448
    v_mfma_f32_16x16x32_bf16 v[108:111], a[140:143], a[100:103], v[108:111]
    s_waitcnt lgkmcnt(4)
    v_exp_f32 v73, v73
    v_mfma_f32_16x16x32_bf16 v[80:83], a[144:147], a[104:107], v[80:83]
    ds_read_b128 a[168:171], v20 offset:16640
    v_cvt_pk_bf16_f32 v122, v72, v73
    v_mfma_f32_16x16x32_bf16 v[84:87], a[144:147], a[108:111], v[84:87]
    v_exp_f32 v74, v74
    v_mfma_f32_16x16x32_bf16 v[88:91], a[148:151], a[104:107], v[88:91]
    ds_read_b128 a[172:175], v20 offset:24832
    v_mfma_f32_16x16x32_bf16 v[92:95], a[148:151], a[108:111], v[92:95]
    s_waitcnt lgkmcnt(4)
    v_exp_f32 v75, v75
    v_mfma_f32_16x16x32_bf16 v[96:99], a[152:155], a[104:107], v[96:99]
    ds_read_b128 a[176:179], v21 offset:256
    v_cvt_pk_bf16_f32 v123, v74, v75
    v_mfma_f32_16x16x32_bf16 v[100:103], a[152:155], a[108:111], v[100:103]
    v_exp_f32 v76, v76
    v_mfma_f32_16x16x32_bf16 v[104:107], a[156:159], a[104:107], v[104:107]
    ds_read_b128 a[180:183], v21 offset:8448
    v_mfma_f32_16x16x32_bf16 v[108:111], a[156:159], a[108:111], v[108:111]
    s_waitcnt lgkmcnt(4)
    v_exp_f32 v77, v77
    v_mfma_f32_16x16x32_bf16 v[80:83], a[160:163], a[112:115], v[80:83]
    ds_read_b128 a[184:187], v21 offset:16640
    v_cvt_pk_bf16_f32 v126, v76, v77
    v_mfma_f32_16x16x32_bf16 v[84:87], a[160:163], a[116:119], v[84:87]
    v_exp_f32 v78, v78
    v_mfma_f32_16x16x32_bf16 v[88:91], a[164:167], a[112:115], v[88:91]
    ds_read_b128 a[188:191], v21 offset:24832
    v_mfma_f32_16x16x32_bf16 v[92:95], a[164:167], a[116:119], v[92:95]
    s_waitcnt lgkmcnt(4)
    v_exp_f32 v79, v79
    v_mfma_f32_16x16x32_bf16 v[96:99], a[168:171], a[112:115], v[96:99]
    s_waitcnt vmcnt(16)
    s_barrier
    ds_read_b64_tr_b16 a[128:129], v30 offset:256
    ds_read_b64_tr_b16 a[130:131], v30 offset:8448
    v_mfma_f32_16x16x32_bf16 v[100:103], a[168:171], a[116:119], v[100:103]
    v_cvt_pk_bf16_f32 v127, v78, v79
    v_mfma_f32_16x16x32_bf16 v[104:107], a[172:175], a[112:115], v[104:107]
    ds_read_b64_tr_b16 a[132:133], v31 offset:256
    ds_read_b64_tr_b16 a[134:135], v31 offset:8448
    v_mfma_f32_16x16x32_bf16 v[108:111], a[172:175], a[116:119], v[108:111]
    s_waitcnt lgkmcnt(6)
    v_mfma_f32_16x16x32_bf16 v[80:83], a[176:179], a[120:123], v[80:83]
    ds_read_b64_tr_b16 a[136:137], v32 offset:256
    ds_read_b64_tr_b16 a[138:139], v32 offset:8448
    v_mfma_f32_16x16x32_bf16 v[84:87], a[176:179], a[124:127], v[84:87]
    v_mfma_f32_16x16x32_bf16 v[88:91], a[180:183], a[120:123], v[88:91]
    ds_read_b64_tr_b16 a[140:141], v33 offset:256
    ds_read_b64_tr_b16 a[142:143], v33 offset:8448
    v_mfma_f32_16x16x32_bf16 v[92:95], a[180:183], a[124:127], v[92:95]
    s_waitcnt lgkmcnt(8)
    v_mfma_f32_16x16x32_bf16 v[96:99], a[184:187], a[120:123], v[96:99]
    ds_read_b64_tr_b16 a[144:145], v34 offset:256
    ds_read_b64_tr_b16 a[146:147], v34 offset:8448
    v_mfma_f32_16x16x32_bf16 v[100:103], a[184:187], a[124:127], v[100:103]
    v_mfma_f32_16x16x32_bf16 v[104:107], a[188:191], a[120:123], v[104:107]
    ds_read_b64_tr_b16 a[148:149], v35 offset:256
    ds_read_b64_tr_b16 a[150:151], v35 offset:8448
    v_mfma_f32_16x16x32_bf16 v[108:111], a[188:191], a[124:127], v[108:111]
    s_mov_b32 s29, 5
L_loop:
    buffer_load_dword v240, off, s[88:91], s95 sc1
    s_waitcnt lgkmcnt(8)
    v_mfma_f32_16x16x32_bf16 v[128:131], a[128:131], v[112:115], v[128:131]
    s_mov_b32 m0, s26
    ds_read_b64_tr_b16 a[152:153], v36 offset:256
    ds_read_b64_tr_b16 a[154:155], v36 offset:8448
    v_mfma_f32_16x16x32_bf16 v[132:135], a[128:131], v[116:119], v[132:135]
    s_add_u32 s30, s23, 4096
    v_mfma_f32_16x16x32_bf16 v[136:139], a[132:135], v[112:115], v[136:139]
    s_add_u32 s25, s25, 32768
    ds_read_b64_tr_b16 a[156:157], v37 offset:256
    ds_read_b64_tr_b16 a[158:159], v37 offset:8448
    v_mfma_f32_16x16x32_bf16 v[140:143], a[132:135], v[116:119], v[140:143]
    s_waitcnt lgkmcnt(8)
    buffer_load_dwordx4 v2, s[8:11], s23 offen offset:0 nt lds
    v_mfma_f32_16x16x32_bf16 v[144:147], a[136:139], v[112:115], v[144:147]
    s_cmp_ge_u32 s25, 163840
    ds_read_b64_tr_b16 a[160:161], v30 offset:16640
    ds_read_b64_tr_b16 a[162:163], v30 offset:24832
    v_mfma_f32_16x16x32_bf16 v[148:151], a[136:139], v[116:119], v[148:151]
    s_cselect_b32 s25, 0, s25
    v_mfma_f32_16x16x32_bf16 v[152:155], a[140:143], v[112:115], v[152:155]
    ds_read_b64_tr_b16 a[164:165], v31 offset:16640
    ds_read_b64_tr_b16 a[166:167], v31 offset:24832
    v_mfma_f32_16x16x32_bf16 v[156:159], a[140:143], v[116:119], v[156:159]
    s_waitcnt lgkmcnt(8)
    buffer_load_dwordx4 v3, s[8:11], s23 offen offset:1024 nt lds
    v_mfma_f32_16x16x32_bf16 v[160:163], a[144:147], v[112:115], v[160:163]
    ds_read_b64_tr_b16 a[168:169], v32 offset:16640
    ds_read_b64_tr_b16 a[170:171], v32 offset:24832
    v_mfma_f32_16x16x32_bf16 v[164:167], a[144:147], v[116:119], v[164:167]
    v_max3_f32 v42, v80, v81, v82
    v_max3_f32 v43, v84, v85, v86
    v_mfma_f32_16x16x32_bf16 v[168:171], a[148:151], v[112:115], v[168:171]
    ds_read_b64_tr_b16 a[172:173], v33 offset:16640
    ds_read_b64_tr_b16 a[174:175], v33 offset:24832
    v_mfma_f32_16x16x32_bf16 v[172:175], a[148:151], v[116:119], v[172:175]
    s_waitcnt lgkmcnt(8)
    buffer_load_dwordx4 v4, s[8:11], s23 offen offset:2048 nt lds
    v_mfma_f32_16x16x32_bf16 v[176:179], a[152:155], v[112:115], v[176:179]
    ds_read_b64_tr_b16 a[176:177], v34 offset:16640
    ds_read_b64_tr_b16 a[178:179], v34 offset:24832
    v_mfma_f32_16x16x32_bf16 v[180:183], a[152:155], v[116:119], v[180:183]
    v_max3_f32 v42, v83, v88, v42
    v_max3_f32 v43, v87, v92, v43
    v_mfma_f32_16x16x32_bf16 v[184:187], a[156:159], v[112:115], v[184:187]
    ds_read_b64_tr_b16 a[180:181], v35 offset:16640
    ds_read_b64_tr_b16 a[182:183], v35 offset:24832
    v_mfma_f32_16x16x32_bf16 v[188:191], a[156:159], v[116:119], v[188:191]
    s_waitcnt lgkmcnt(8)
    buffer_load_dwordx4 v5, s[8:11], s23 offen offset:3072 nt lds
    v_mfma_f32_16x16x32_bf16 v[128:131], a[160:163], v[120:123], v[128:131]
    s_add_u32 m0, s26, 4096
    ds_read_b64_tr_b16 a[184:185], v36 offset:16640
    ds_read_b64_tr_b16 a[186:187], v36 offset:24832
    v_mfma_f32_16x16x32_bf16 v[132:135], a[160:163], v[124:127], v[132:135]
    s_add_u32 s23, s23, 32768
    v_max3_f32 v42, v89, v90, v42
    v_max3_f32 v43, v93, v94, v43
    v_mfma_f32_16x16x32_bf16 v[136:139], a[164:167], v[120:123], v[136:139]
    ds_read_b64_tr_b16 a[188:189], v37 offset:16640
    ds_read_b64_tr_b16 a[190:191], v37 offset:24832
    v_mfma_f32_16x16x32_bf16 v[140:143], a[164:167], v[124:127], v[140:143]
    s_waitcnt lgkmcnt(8)
    buffer_load_dwordx4 v6, s[8:11], s30 offen offset:0 nt lds
    v_mfma_f32_16x16x32_bf16 v[144:147], a[168:171], v[120:123], v[144:147]
    v_max3_f32 v42, v91, v96, v42
    v_max3_f32 v43, v95, v100, v43
    v_mfma_f32_16x16x32_bf16 v[148:151], a[168:171], v[124:127], v[148:151]
    v_max3_f32 v42, v97, v98, v42
    v_max3_f32 v43, v101, v102, v43
    v_mfma_f32_16x16x32_bf16 v[152:155], a[172:175], v[120:123], v[152:155]
    v_max3_f32 v42, v99, v104, v42
    v_max3_f32 v43, v103, v108, v43
    v_mfma_f32_16x16x32_bf16 v[156:159], a[172:175], v[124:127], v[156:159]
    s_waitcnt lgkmcnt(4)
    buffer_load_dwordx4 v7, s[8:11], s30 offen offset:1024 nt lds
    v_mfma_f32_16x16x32_bf16 v[160:163], a[176:179], v[120:123], v[160:163]
    ds_read_b64_tr_b16 a[128:129], v30 offset:0
    ds_read_b64_tr_b16 a[130:131], v30 offset:8192
    v_mfma_f32_16x16x32_bf16 v[164:167], a[176:179], v[124:127], v[164:167]
    v_max3_f32 v42, v105, v106, v42
    v_max3_f32 v43, v109, v110, v43
    v_mfma_f32_16x16x32_bf16 v[168:171], a[180:183], v[120:123], v[168:171]
    ds_read_b64_tr_b16 a[132:133], v31 offset:0
    ds_read_b64_tr_b16 a[134:135], v31 offset:8192
    v_mfma_f32_16x16x32_bf16 v[172:175], a[180:183], v[124:127], v[172:175]
    s_waitcnt lgkmcnt(4)
    buffer_load_dwordx4 v8, s[8:11], s30 offen offset:2048 nt lds
    v_mfma_f32_16x16x32_bf16 v[176:179], a[184:187], v[120:123], v[176:179]
    ds_read_b64_tr_b16 a[136:137], v32 offset:0
    ds_read_b64_tr_b16 a[138:139], v32 offset:8192
    v_mfma_f32_16x16x32_bf16 v[180:183], a[184:187], v[124:127], v[180:183]
    v_max_f32 v42, v107, v42
    v_max_f32 v43, v111, v43
    v_mfma_f32_16x16x32_bf16 v[184:187], a[188:191], v[120:123], v[184:187]
    ds_read_b64_tr_b16 a[140:141], v33 offset:0
    ds_read_b64_tr_b16 a[142:143], v33 offset:8192
    v_mfma_f32_16x16x32_bf16 v[188:191], a[188:191], v[124:127], v[188:191]
    buffer_load_dwordx4 v9, s[8:11], s30 offen offset:3072 nt lds
    v_mfma_f32_16x16x32_bf16 a[196:199], a[192:195], v[112:115], a[196:199]
    ds_read_b64_tr_b16 a[144:145], v34 offset:0
    ds_read_b64_tr_b16 a[146:147], v34 offset:8192
    v_mfma_f32_16x16x32_bf16 a[200:203], a[192:195], v[116:119], a[200:203]
    v_max_f32 v44, v42, v43
    v_add_u32 v18, s25, v14
    v_mfma_f32_16x16x32_bf16 a[196:199], a[192:195], v[120:123], a[196:199]
    ds_read_b64_tr_b16 a[148:149], v35 offset:0
    ds_read_b64_tr_b16 a[150:151], v35 offset:8192
    v_mfma_f32_16x16x32_bf16 a[200:203], a[192:195], v[124:127], a[200:203]
    s_waitcnt lgkmcnt(8)
    v_cmp_lt_f32 vcc, s22, v44
    v_add_u32 v19, s25, v15
    v_mfma_f32_16x16x32_bf16 a[0:3], a[128:131], v[112:115], a[0:3]
    s_cbranch_vccnz L_rare_4
L_back_4:
    ds_read_b64_tr_b16 a[152:153], v36 offset:0
    ds_read_b64_tr_b16 a[154:155], v36 offset:8192
    v_mfma_f32_16x16x32_bf16 a[4:7], a[128:131], v[116:119], a[4:7]
    s_add_u32 s26, s26, 32768
    v_exp_f32 v80, v80
    v_mfma_f32_16x16x32_bf16 a[8:11], a[132:135], v[112:115], a[8:11]
    s_cmp_ge_u32 s26, 163840
    ds_read_b64_tr_b16 a[156:157], v37 offset:0
    ds_read_b64_tr_b16 a[158:159], v37 offset:8192
    v_mfma_f32_16x16x32_bf16 a[12:15], a[132:135], v[116:119], a[12:15]
    s_waitcnt lgkmcnt(8)
    v_exp_f32 v81, v81
    v_mfma_f32_16x16x32_bf16 a[16:19], a[136:139], v[112:115], a[16:19]
    s_cselect_b32 s26, s34, s26
    ds_read_b64_tr_b16 a[160:161], v30 offset:16384
    ds_read_b64_tr_b16 a[162:163], v30 offset:24576
    v_mfma_f32_16x16x32_bf16 a[20:23], a[136:139], v[116:119], a[20:23]
    v_exp_f32 v82, v82
    v_mfma_f32_16x16x32_bf16 a[24:27], a[140:143], v[112:115], a[24:27]
    ds_read_b64_tr_b16 a[164:165], v31 offset:16384
    ds_read_b64_tr_b16 a[166:167], v31 offset:24576
    v_mfma_f32_16x16x32_bf16 a[28:31], a[140:143], v[116:119], a[28:31]
    s_waitcnt lgkmcnt(8)
    v_exp_f32 v83, v83
    v_mfma_f32_16x16x32_bf16 a[32:35], a[144:147], v[112:115], a[32:35]
    ds_read_b64_tr_b16 a[168:169], v32 offset:16384
    ds_read_b64_tr_b16 a[170:171], v32 offset:24576
    v_mfma_f32_16x16x32_bf16 a[36:39], a[144:147], v[116:119], a[36:39]
    v_exp_f32 v84, v84
    v_mfma_f32_16x16x32_bf16 a[40:43], a[148:151], v[112:115], a[40:43]
    ds_read_b64_tr_b16 a[172:173], v33 offset:16384
    ds_read_b64_tr_b16 a[174:175], v33 offset:24576
    v_mfma_f32_16x16x32_bf16 a[44:47], a[148:151], v[116:119], a[44:47]
    s_waitcnt lgkmcnt(8)
    v_exp_f32 v85, v85
    v_mfma_f32_16x16x32_bf16 a[48:51], a[152:155], v[112:115], a[48:51]
    ds_read_b64_tr_b16 a[176:177], v34 offset:16384
    ds_read_b64_tr_b16 a[178:179], v34 offset:24576
    v_mfma_f32_16x16x32_bf16 a[52:55], a[152:155], v[116:119], a[52:55]
    v_exp_f32 v86, v86
    v_mfma_f32_16x16x32_bf16 a[56:59], a[156:159], v[112:115], a[56:59]
    ds_read_b64_tr_b16 a[180:181], v35 offset:16384
    ds_read_b64_tr_b16 a[182:183], v35 offset:24576
    v_mfma_f32_16x16x32_bf16 a[60:63], a[156:159], v[116:119], a[60:63]
    s_waitcnt lgkmcnt(8)
    v_add_u32 v20, s25, v16
    v_add_u32 v21, s25, v17
    v_mfma_f32_16x16x32_bf16 a[0:3], a[160:163], v[120:123], a[0:3]
    ds_read_b64_tr_b16 a[184:185], v36 offset:16384
    ds_read_b64_tr_b16 a[186:187], v36 offset:24576
    v_mfma_f32_16x16x32_bf16 a[4:7], a[160:163], v[124:127], a[4:7]
    v_exp_f32 v87, v87
    v_mfma_f32_16x16x32_bf16 a[8:11], a[164:167], v[120:123], a[8:11]
    ds_read_b64_tr_b16 a[188:189], v37 offset:16384
    ds_read_b64_tr_b16 a[190:191], v37 offset:24576
    v_mfma_f32_16x16x32_bf16 a[12:15], a[164:167], v[124:127], a[12:15]
    s_waitcnt lgkmcnt(8)
    v_exp_f32 v88, v88
    v_mfma_f32_16x16x32_bf16 a[16:19], a[168:171], v[120:123], a[16:19]
    s_waitcnt vmcnt(16)
    s_barrier
    ds_read_b128 a[128:131], v18 offset:0
    v_cvt_pk_bf16_f32 v192, v80, v81
    v_mfma_f32_16x16x32_bf16 a[20:23], a[168:171], v[124:127], a[20:23]
    v_exp_f32 v89, v89
    v_mfma_f32_16x16x32_bf16 a[24:27], a[172:175], v[120:123], a[24:27]
    ds_read_b128 a[132:135], v18 offset:8192
    v_cvt_pk_bf16_f32 v193, v82, v83
    v_mfma_f32_16x16x32_bf16 a[28:31], a[172:175], v[124:127], a[28:31]
    s_waitcnt lgkmcnt(6)
    v_exp_f32 v90, v90
    v_mfma_f32_16x16x32_bf16 a[32:35], a[176:179], v[120:123], a[32:35]
    ds_read_b128 a[136:139], v18 offset:16384
    v_cvt_pk_bf16_f32 v196, v84, v85
    v_mfma_f32_16x16x32_bf16 a[36:39], a[176:179], v[124:127], a[36:39]
    v_exp_f32 v91, v91
    v_mfma_f32_16x16x32_bf16 a[40:43], a[180:183], v[120:123], a[40:43]
    ds_read_b128 a[140:143], v18 offset:24576
    v_cvt_pk_bf16_f32 v197, v86, v87
    v_mfma_f32_16x16x32_bf16 a[44:47], a[180:183], v[124:127], a[44:47]
    s_waitcnt lgkmcnt(4)
    v_exp_f32 v92, v92
    v_mfma_f32_16x16x32_bf16 a[48:51], a[184:187], v[120:123], a[48:51]
    ds_read_b128 a[144:147], v19 offset:0
    v_cvt_pk_bf16_f32 v194, v88, v89
    v_mfma_f32_16x16x32_bf16 a[52:55], a[184:187], v[124:127], a[52:55]
    v_exp_f32 v93, v93
    v_mfma_f32_16x16x32_bf16 a[56:59], a[188:191], v[120:123], a[56:59]
    ds_read_b128 a[148:151], v19 offset:8192
    v_cvt_pk_bf16_f32 v195, v90, v91
    v_mfma_f32_16x16x32_bf16 a[60:63], a[188:191], v[124:127], a[60:63]
    s_waitcnt lgkmcnt(4)
    v_exp_f32 v94, v94
    v_mfma_f32_16x16x32_bf16 v[48:51], a[128:131], a[64:67], v[244:247]
    s_mov_b32 m0, s26
    ds_read_b128 a[152:155], v19 offset:16384
    v_cvt_pk_bf16_f32 v198, v92, v93
    v_mfma_f32_16x16x32_bf16 v[52:55], a[128:131], a[68:71], v[248:251]
    s_add_u32 s30, s24, 4096
    v_exp_f32 v95, v95
    v_mfma_f32_16x16x32_bf16 v[56:59], a[132:135], a[64:67], v[244:247]
    s_add_u32 s25, s25, 32768
    ds_read_b128 a[156:159], v19 offset:24576
    v_cvt_pk_bf16_f32 v199, v94, v95
    v_mfma_f32_16x16x32_bf16 v[60:63], a[132:135], a[68:71], v[248:251]
    s_waitcnt lgkmcnt(4)
    buffer_load_dwordx4 v10, s[12:15], s24 offen offset:0 nt lds
    v_mfma_f32_16x16x32_bf16 v[64:67], a[136:139], a[64:67], v[244:247]
    s_cmp_ge_u32 s25, 163840
    ds_read_b128 a[160:163], v20 offset:0
    v_mfma_f32_16x16x32_bf16 v[68:71], a[136:139], a[68:71], v[248:251]
    s_cselect_b32 s25, 0, s25
    buffer_load_dwordx4 v11, s[12:15], s24 offen offset:1024 nt lds
    v_mfma_f32_16x16x32_bf16 v[72:75], a[140:143], a[64:67], v[244:247]
    ds_read_b128 a[164:167], v20 offset:8192
    v_add_u32 v30, s25, v22
    v_mfma_f32_16x16x32_bf16 v[76:79], a[140:143], a[68:71], v[248:251]
    s_waitcnt lgkmcnt(4)
    v_exp_f32 v96, v96
    v_mfma_f32_16x16x32_bf16 v[48:51], a[144:147], a[72:75], v[48:51]
    ds_read_b128 a[168:171], v20 offset:16384
    v_add_u32 v31, s25, v23
    v_mfma_f32_16x16x32_bf16 v[52:55], a[144:147], a[76:79], v[52:55]
    buffer_load_dwordx4 v12, s[12:15], s24 offen offset:2048 nt lds
    v_mfma_f32_16x16x32_bf16 v[56:59], a[148:151], a[72:75], v[56:59]
    ds_read_b128 a[172:175], v20 offset:24576
    v_add_u32 v32, s25, v24
    v_mfma_f32_16x16x32_bf16 v[60:63], a[148:151], a[76:79], v[60:63]
    s_waitcnt lgkmcnt(4)
    v_exp_f32 v97, v97
    v_mfma_f32_16x16x32_bf16 v[64:67], a[152:155], a[72:75], v[64:67]
    ds_read_b128 a[176:179], v21 offset:0
    v_add_u32 v33, s25, v25
    v_mfma_f32_16x16x32_bf16 v[68:71], a[152:155], a[76:79], v[68:71]
    buffer_load_dwordx4 v13, s[12:15], s24 offen offset:3072 nt lds
    v_mfma_f32_16x16x32_bf16 v[72:75], a[156:159], a[72:75], v[72:75]
    s_add_u32 m0, s26, 4096
    ds_read_b128 a[180:183], v21 offset:8192
    v_add_u32 v34, s25, v26
    v_mfma_f32_16x16x32_bf16 v[76:79], a[156:159], a[76:79], v[76:79]
    s_waitcnt lgkmcnt(4)
    v_exp_f32 v98, v98
    v_mfma_f32_16x16x32_bf16 v[48:51], a[160:163], a[80:83], v[48:51]
    s_add_u32 s24, s24, 32768
    ds_read_b128 a[184:187], v21 offset:16384
    v_add_u32 v35, s25, v27
    v_mfma_f32_16x16x32_bf16 v[52:55], a[160:163], a[84:87], v[52:55]
    buffer_load_dwordx4 v10, s[12:15], s30 offen offset:0 nt lds
    v_mfma_f32_16x16x32_bf16 v[56:59], a[164:167], a[80:83], v[56:59]
    ds_read_b128 a[188:191], v21 offset:24576
    v_add_u32 v36, s25, v28
    v_mfma_f32_16x16x32_bf16 v[60:63], a[164:167], a[84:87], v[60:63]
    s_waitcnt lgkmcnt(4)
    v_exp_f32 v99, v99
    v_mfma_f32_16x16x32_bf16 v[64:67], a[168:171], a[80:83], v[64:67]
    ds_read_b128 a[128:131], v18 offset:256
    v_add_u32 v37, s25, v29
    v_mfma_f32_16x16x32_bf16 v[68:71], a[168:171], a[84:87], v[68:71]
    buffer_load_dwordx4 v11, s[12:15], s30 offen offset:1024 nt lds
    v_mfma_f32_16x16x32_bf16 v[72:75], a[172:175], a[80:83], v[72:75]
    ds_read_b128 a[132:135], v18 offset:8448
    v_cvt_pk_bf16_f32 v200, v96, v97
    v_mfma_f32_16x16x32_bf16 v[76:79], a[172:175], a[84:87], v[76:79]
    s_waitcnt lgkmcnt(4)
    v_exp_f32 v100, v100
    v_mfma_f32_16x16x32_bf16 v[48:51], a[176:179], a[88:91], v[48:51]
    ds_read_b128 a[136:139], v18 offset:16640
    v_cvt_pk_bf16_f32 v201, v98, v99
    v_mfma_f32_16x16x32_bf16 v[52:55], a[176:179], a[92:95], v[52:55]
    buffer_load_dwordx4 v12, s[12:15], s30 offen offset:2048 nt lds
    v_mfma_f32_16x16x32_bf16 v[56:59], a[180:183], a[88:91], v[56:59]
    ds_read_b128 a[140:143], v18 offset:24832
    v_mfma_f32_16x16x32_bf16 v[60:63], a[180:183], a[92:95], v[60:63]
    s_waitcnt lgkmcnt(4)
    v_exp_f32 v101, v101
    v_mfma_f32_16x16x32_bf16 v[64:67], a[184:187], a[88:91], v[64:67]
    ds_read_b128 a[144:147], v19 offset:256
    v_cvt_pk_bf16_f32 v204, v100, v101
    v_mfma_f32_16x16x32_bf16 v[68:71], a[184:187], a[92:95], v[68:71]
    buffer_load_dwordx4 v13, s[12:15], s30 offen offset:3072 nt lds
    v_mfma_f32_16x16x32_bf16 v[72:75], a[188:191], a[88:91], v[72:75]
    s_add_u32 s26, s26, 32768
    ds_read_b128 a[148:151], v19 offset:8448
    v_mfma_f32_16x16x32_bf16 v[76:79], a[188:191], a[92:95], v[76:79]
    s_waitcnt lgkmcnt(4)
    v_exp_f32 v102, v102
    v_mfma_f32_16x16x32_bf16 v[48:51], a[128:131], a[96:99], v[48:51]
    s_cmp_ge_u32 s26, 163840
    ds_read_b128 a[152:155], v19 offset:16640
    v_mfma_f32_16x16x32_bf16 v[52:55], a[128:131], a[100:103], v[52:55]
    s_cselect_b32 s26, s34, s26
    v_exp_f32 v103, v103
    v_mfma_f32_16x16x32_bf16 v[56:59], a[132:135], a[96:99], v[56:59]
    ds_read_b128 a[156:159], v19 offset:24832
    v_cvt_pk_bf16_f32 v205, v102, v103
    v_mfma_f32_16x16x32_bf16 v[60:63], a[132:135], a[100:103], v[60:63]
    s_waitcnt lgkmcnt(4)
    v_exp_f32 v104, v104
    v_mfma_f32_16x16x32_bf16 v[64:67], a[136:139], a[96:99], v[64:67]
    ds_read_b128 a[160:163], v20 offset:256
    v_mfma_f32_16x16x32_bf16 v[68:71], a[136:139], a[100:103], v[68:71]
    v_exp_f32 v105, v105
    v_mfma_f32_16x16x32_bf16 v[72:75], a[140:143], a[96:99], v[72:75]
    ds_read_b128 a[164:167], v20 offset:8448
    v_cvt_pk_bf16_f32 v202, v104, v105
    v_mfma_f32_16x16x32_bf16 v[76:79], a[140:143], a[100:103], v[76:79]
    s_waitcnt lgkmcnt(4)
    v_exp_f32 v106, v106
    v_mfma_f32_16x16x32_bf16 v[48:51], a[144:147], a[104:107], v[48:51]
    ds_read_b128 a[168:171], v20 offset:16640
    v_mfma_f32_16x16x32_bf16 v[52:55], a[144:147], a[108:111], v[52:55]
    v_exp_f32 v107, v107
    v_mfma_f32_16x16x32_bf16 v[56:59], a[148:151], a[104:107], v[56:59]
    ds_read_b128 a[172:175], v20 offset:24832
    v_cvt_pk_bf16_f32 v203, v106, v107
    v_mfma_f32_16x16x32_bf16 v[60:63], a[148:151], a[108:111], v[60:63]
    s_waitcnt lgkmcnt(4)
    v_exp_f32 v108, v108
    v_mfma_f32_16x16x32_bf16 v[64:67], a[152:155], a[104:107], v[64:67]
    ds_read_b128 a[176:179], v21 offset:256
    v_mfma_f32_16x16x32_bf16 v[68:71], a[152:155], a[108:111], v[68:71]
    v_exp_f32 v109, v109
    v_mfma_f32_16x16x32_bf16 v[72:75], a[156:159], a[104:107], v[72:75]
    ds_read_b128 a[180:183], v21 offset:8448
    v_cvt_pk_bf16_f32 v206, v108, v109
    v_mfma_f32_16x16x32_bf16 v[76:79], a[156:159], a[108:111], v[76:79]
    s_waitcnt lgkmcnt(4)
    v_exp_f32 v110, v110
    v_mfma_f32_16x16x32_bf16 v[48:51], a[160:163], a[112:115], v[48:51]
    ds_read_b128 a[184:187], v21 offset:16640
    v_mfma_f32_16x16x32_bf16 v[52:55], a[160:163], a[116:119], v[52:55]
    v_exp_f32 v111, v111
    v_mfma_f32_16x16x32_bf16 v[56:59], a[164:167], a[112:115], v[56:59]
    ds_read_b128 a[188:191], v21 offset:24832
    v_cvt_pk_bf16_f32 v207, v110, v111
    v_mfma_f32_16x16x32_bf16 v[60:63], a[164:167], a[116:119], v[60:63]
    s_waitcnt lgkmcnt(4)
    v_mfma_f32_16x16x32_bf16 v[64:67], a[168:171], a[112:115], v[64:67]
    s_waitcnt vmcnt(16)
    s_barrier
    ds_read_b64_tr_b16 a[128:129], v30 offset:256
    ds_read_b64_tr_b16 a[130:131], v30 offset:8448
    v_mfma_f32_16x16x32_bf16 v[68:71], a[168:171], a[116:119], v[68:71]
    v_mfma_f32_16x16x32_bf16 v[72:75], a[172:175], a[112:115], v[72:75]
    ds_read_b64_tr_b16 a[132:133], v31 offset:256
    ds_read_b64_tr_b16 a[134:135], v31 offset:8448
    v_mfma_f32_16x16x32_bf16 v[76:79], a[172:175], a[116:119], v[76:79]
    s_waitcnt lgkmcnt(6)
    v_mfma_f32_16x16x32_bf16 v[48:51], a[176:179], a[120:123], v[48:51]
    ds_read_b64_tr_b16 a[136:137], v32 offset:256
    ds_read_b64_tr_b16 a[138:139], v32 offset:8448
    v_mfma_f32_16x16x32_bf16 v[52:55], a[176:179], a[124:127], v[52:55]
    v_mfma_f32_16x16x32_bf16 v[56:59], a[180:183], a[120:123], v[56:59]
    ds_read_b64_tr_b16 a[140:141], v33 offset:256
    ds_read_b64_tr_b16 a[142:143], v33 offset:8448
    v_mfma_f32_16x16x32_bf16 v[60:63], a[180:183], a[124:127], v[60:63]
    s_waitcnt lgkmcnt(8)
    v_mfma_f32_16x16x32_bf16 v[64:67], a[184:187], a[120:123], v[64:67]
    ds_read_b64_tr_b16 a[144:145], v34 offset:256
    ds_read_b64_tr_b16 a[146:147], v34 offset:8448
    v_mfma_f32_16x16x32_bf16 v[68:71], a[184:187], a[124:127], v[68:71]
    v_mfma_f32_16x16x32_bf16 v[72:75], a[188:191], a[120:123], v[72:75]
    ds_read_b64_tr_b16 a[148:149], v35 offset:256
    ds_read_b64_tr_b16 a[150:151], v35 offset:8448
    v_mfma_f32_16x16x32_bf16 v[76:79], a[188:191], a[124:127], v[76:79]
    s_waitcnt lgkmcnt(8)
    v_mfma_f32_16x16x32_bf16 v[128:131], a[128:131], v[192:195], v[128:131]
    s_mov_b32 m0, s26
    ds_read_b64_tr_b16 a[152:153], v36 offset:256
    ds_read_b64_tr_b16 a[154:155], v36 offset:8448
    v_mfma_f32_16x16x32_bf16 v[132:135], a[128:131], v[196:199], v[132:135]
    s_add_u32 s30, s23, 4096
    v_mfma_f32_16x16x32_bf16 v[136:139], a[132:135], v[192:195], v[136:139]
    s_add_u32 s25, s25, 32768
    ds_read_b64_tr_b16 a[156:157], v37 offset:256
    ds_read_b64_tr_b16 a[158:159], v37 offset:8448
    v_mfma_f32_16x16x32_bf16 v[140:143], a[132:135], v[196:199], v[140:143]
    s_waitcnt lgkmcnt(8)
    buffer_load_dwordx4 v2, s[8:11], s23 offen offset:0 nt lds
    v_mfma_f32_16x16x32_bf16 v[144:147], a[136:139], v[192:195], v[144:147]
    s_cmp_ge_u32 s25, 163840
    ds_read_b64_tr_b16 a[160:161], v30 offset:16640
    ds_read_b64_tr_b16 a[162:163], v30 offset:24832
    v_mfma_f32_16x16x32_bf16 v[148:151], a[136:139], v[196:199], v[148:151]
    s_cselect_b32 s25, 0, s25
    v_mfma_f32_16x16x32_bf16 v[152:155], a[140:143], v[192:195], v[152:155]
    ds_read_b64_tr_b16 a[164:165], v31 offset:16640
    ds_read_b64_tr_b16 a[166:167], v31 offset:24832
    v_mfma_f32_16x16x32_bf16 v[156:159], a[140:143], v[196:199], v[156:159]
    s_waitcnt lgkmcnt(8)
    buffer_load_dwordx4 v3, s[8:11], s23 offen offset:1024 nt lds
    v_mfma_f32_16x16x32_bf16 v[160:163], a[144:147], v[192:195], v[160:163]
    ds_read_b64_tr_b16 a[168:169], v32 offset:16640
    ds_read_b64_tr_b16 a[170:171], v32 offset:24832
    v_mfma_f32_16x16x32_bf16 v[164:167], a[144:147], v[196:199], v[164:167]
    v_max3_f32 v42, v48, v49, v50
    v_max3_f32 v43, v52, v53, v54
    v_mfma_f32_16x16x32_bf16 v[168:171], a[148:151], v[192:195], v[168:171]
    ds_read_b64_tr_b16 a[172:173], v33 offset:16640
    ds_read_b64_tr_b16 a[174:175], v33 offset:24832
    v_mfma_f32_16x16x32_bf16 v[172:175], a[148:151], v[196:199], v[172:175]
    s_waitcnt lgkmcnt(8)
    buffer_load_dwordx4 v4, s[8:11], s23 offen offset:2048 nt lds
    v_mfma_f32_16x16x32_bf16 v[176:179], a[152:155], v[192:195], v[176:179]
    ds_read_b64_tr_b16 a[176:177], v34 offset:16640
    ds_read_b64_tr_b16 a[178:179], v34 offset:24832
    v_mfma_f32_16x16x32_bf16 v[180:183], a[152:155], v[196:199], v[180:183]
    v_max3_f32 v42, v51, v56, v42
    v_max3_f32 v43, v55, v60, v43
    v_mfma_f32_16x16x32_bf16 v[184:187], a[156:159], v[192:195], v[184:187]
    ds_read_b64_tr_b16 a[180:181], v35 offset:16640
    ds_read_b64_tr_b16 a[182:183], v35 offset:24832
    v_mfma_f32_16x16x32_bf16 v[188:191], a[156:159], v[196:199], v[188:191]
    s_waitcnt lgkmcnt(8)
    buffer_load_dwordx4 v5, s[8:11], s23 offen offset:3072 nt lds
    v_mfma_f32_16x16x32_bf16 v[128:131], a[160:163], v[200:203], v[128:131]
    s_add_u32 m0, s26, 4096
    ds_read_b64_tr_b16 a[184:185], v36 offset:16640
    ds_read_b64_tr_b16 a[186:187], v36 offset:24832
    v_mfma_f32_16x16x32_bf16 v[132:135], a[160:163], v[204:207], v[132:135]
    s_add_u32 s23, s23, 32768
    v_max3_f32 v42, v57, v58, v42
    v_max3_f32 v43, v61, v62, v43
    v_mfma_f32_16x16x32_bf16 v[136:139], a[164:167], v[200:203], v[136:139]
    ds_read_b64_tr_b16 a[188:189], v37 offset:16640
    ds_read_b64_tr_b16 a[190:191], v37 offset:24832
    v_mfma_f32_16x16x32_bf16 v[140:143], a[164:167], v[204:207], v[140:143]
    s_waitcnt lgkmcnt(8)
    buffer_load_dwordx4 v6, s[8:11], s30 offen offset:0 nt lds
    v_mfma_f32_16x16x32_bf16 v[144:147], a[168:171], v[200:203], v[144:147]
    v_max3_f32 v42, v59, v64, v42
    v_max3_f32 v43, v63, v68, v43
    v_mfma_f32_16x16x32_bf16 v[148:151], a[168:171], v[204:207], v[148:151]
    v_max3_f32 v42, v65, v66, v42
    v_max3_f32 v43, v69, v70, v43
    v_mfma_f32_16x16x32_bf16 v[152:155], a[172:175], v[200:203], v[152:155]
    v_max3_f32 v42, v67, v72, v42
    v_max3_f32 v43, v71, v76, v43
    v_mfma_f32_16x16x32_bf16 v[156:159], a[172:175], v[204:207], v[156:159]
    s_waitcnt lgkmcnt(4)
    buffer_load_dwordx4 v7, s[8:11], s30 offen offset:1024 nt lds
    v_mfma_f32_16x16x32_bf16 v[160:163], a[176:179], v[200:203], v[160:163]
    ds_read_b64_tr_b16 a[128:129], v30 offset:0
    ds_read_b64_tr_b16 a[130:131], v30 offset:8192
    v_mfma_f32_16x16x32_bf16 v[164:167], a[176:179], v[204:207], v[164:167]
    v_max3_f32 v42, v73, v74, v42
    v_max3_f32 v43, v77, v78, v43
    v_mfma_f32_16x16x32_bf16 v[168:171], a[180:183], v[200:203], v[168:171]
    ds_read_b64_tr_b16 a[132:133], v31 offset:0
    ds_read_b64_tr_b16 a[134:135], v31 offset:8192
    v_mfma_f32_16x16x32_bf16 v[172:175], a[180:183], v[204:207], v[172:175]
    s_waitcnt lgkmcnt(4)
    buffer_load_dwordx4 v8, s[8:11], s30 offen offset:2048 nt lds
    v_mfma_f32_16x16x32_bf16 v[176:179], a[184:187], v[200:203], v[176:179]
    ds_read_b64_tr_b16 a[136:137], v32 offset:0
    ds_read_b64_tr_b16 a[138:139], v32 offset:8192
    v_mfma_f32_16x16x32_bf16 v[180:183], a[184:187], v[204:207], v[180:183]
    v_max_f32 v42, v75, v42
    v_max_f32 v43, v79, v43
    v_mfma_f32_16x16x32_bf16 v[184:187], a[188:191], v[200:203], v[184:187]
    ds_read_b64_tr_b16 a[140:141], v33 offset:0
    ds_read_b64_tr_b16 a[142:143], v33 offset:8192
    v_mfma_f32_16x16x32_bf16 v[188:191], a[188:191], v[204:207], v[188:191]
    buffer_load_dwordx4 v9, s[8:11], s30 offen offset:3072 nt lds
    v_mfma_f32_16x16x32_bf16 a[196:199], a[192:195], v[192:195], a[196:199]
    ds_read_b64_tr_b16 a[144:145], v34 offset:0
    ds_read_b64_tr_b16 a[146:147], v34 offset:8192
    v_mfma_f32_16x16x32_bf16 a[200:203], a[192:195], v[196:199], a[200:203]
    v_max_f32 v44, v42, v43
    v_add_u32 v18, s25, v14
    v_mfma_f32_16x16x32_bf16 a[196:199], a[192:195], v[200:203], a[196:199]
    ds_read_b64_tr_b16 a[148:149], v35 offset:0
    ds_read_b64_tr_b16 a[150:151], v35 offset:8192
    v_mfma_f32_16x16x32_bf16 a[200:203], a[192:195], v[204:207], a[200:203]
    s_waitcnt lgkmcnt(8)
    v_cmp_lt_f32 vcc, s22, v44
    v_add_u32 v19, s25, v15
    v_mfma_f32_16x16x32_bf16 a[0:3], a[128:131], v[192:195], a[0:3]
    s_cbranch_vccnz L_rare_5
L_back_5:
    ds_read_b64_tr_b16 a[152:153], v36 offset:0
    ds_read_b64_tr_b16 a[154:155], v36 offset:8192
    v_mfma_f32_16x16x32_bf16 a[4:7], a[128:131], v[196:199], a[4:7]
    s_add_u32 s26, s26, 32768
    v_exp_f32 v48, v48
    v_mfma_f32_16x16x32_bf16 a[8:11], a[132:135], v[192:195], a[8:11]
    s_cmp_ge_u32 s26, 163840
    ds_read_b64_tr_b16 a[156:157], v37 offset:0
    ds_read_b64_tr_b16 a[158:159], v37 offset:8192
    v_mfma_f32_16x16x32_bf16 a[12:15], a[132:135], v[196:199], a[12:15]
    s_waitcnt lgkmcnt(8)
    v_exp_f32 v49, v49
    v_mfma_f32_16x16x32_bf16 a[16:19], a[136:139], v[192:195], a[16:19]
    s_cselect_b32 s26, s34, s26
    ds_read_b64_tr_b16 a[160:161], v30 offset:16384
    ds_read_b64_tr_b16 a[162:163], v30 offset:24576
    v_mfma_f32_16x16x32_bf16 a[20:23], a[136:139], v[196:199], a[20:23]
    v_exp_f32 v50, v50
    v_mfma_f32_16x16x32_bf16 a[24:27], a[140:143], v[192:195], a[24:27]
    ds_read_b64_tr_b16 a[164:165], v31 offset:16384
    ds_read_b64_tr_b16 a[166:167], v31 offset:24576
    v_mfma_f32_16x16x32_bf16 a[28:31], a[140:143], v[196:199], a[28:31]
    s_waitcnt lgkmcnt(8)
    v_exp_f32 v51, v51
    v_mfma_f32_16x16x32_bf16 a[32:35], a[144:147], v[192:195], a[32:35]
    ds_read_b64_tr_b16 a[168:169], v32 offset:16384
    ds_read_b64_tr_b16 a[170:171], v32 offset:24576
    v_mfma_f32_16x16x32_bf16 a[36:39], a[144:147], v[196:199], a[36:39]
    v_exp_f32 v52, v52
    v_mfma_f32_16x16x32_bf16 a[40:43], a[148:151], v[192:195], a[40:43]
    ds_read_b64_tr_b16 a[172:173], v33 offset:16384
    ds_read_b64_tr_b16 a[174:175], v33 offset:24576
    v_mfma_f32_16x16x32_bf16 a[44:47], a[148:151], v[196:199], a[44:47]
    s_waitcnt lgkmcnt(8)
    v_exp_f32 v53, v53
    v_mfma_f32_16x16x32_bf16 a[48:51], a[152:155], v[192:195], a[48:51]
    ds_read_b64_tr_b16 a[176:177], v34 offset:16384
    ds_read_b64_tr_b16 a[178:179], v34 offset:24576
    v_mfma_f32_16x16x32_bf16 a[52:55], a[152:155], v[196:199], a[52:55]
    v_exp_f32 v54, v54
    v_mfma_f32_16x16x32_bf16 a[56:59], a[156:159], v[192:195], a[56:59]
    ds_read_b64_tr_b16 a[180:181], v35 offset:16384
    ds_read_b64_tr_b16 a[182:183], v35 offset:24576
    v_mfma_f32_16x16x32_bf16 a[60:63], a[156:159], v[196:199], a[60:63]
    s_waitcnt lgkmcnt(8)
    v_add_u32 v20, s25, v16
    v_add_u32 v21, s25, v17
    v_mfma_f32_16x16x32_bf16 a[0:3], a[160:163], v[200:203], a[0:3]
    ds_read_b64_tr_b16 a[184:185], v36 offset:16384
    ds_read_b64_tr_b16 a[186:187], v36 offset:24576
    v_mfma_f32_16x16x32_bf16 a[4:7], a[160:163], v[204:207], a[4:7]
    v_exp_f32 v55, v55
    v_mfma_f32_16x16x32_bf16 a[8:11], a[164:167], v[200:203], a[8:11]
    ds_read_b64_tr_b16 a[188:189], v37 offset:16384
    ds_read_b64_tr_b16 a[190:191], v37 offset:24576
    v_mfma_f32_16x16x32_bf16 a[12:15], a[164:167], v[204:207], a[12:15]
    s_waitcnt lgkmcnt(8)
    v_exp_f32 v56, v56
    v_mfma_f32_16x16x32_bf16 a[16:19], a[168:171], v[200:203], a[16:19]
    s_waitcnt vmcnt(16)
    s_barrier
    ds_read_b128 a[128:131], v18 offset:0
    v_cvt_pk_bf16_f32 v112, v48, v49
    v_mfma_f32_16x16x32_bf16 a[20:23], a[168:171], v[204:207], a[20:23]
    v_exp_f32 v57, v57
    v_mfma_f32_16x16x32_bf16 a[24:27], a[172:175], v[200:203], a[24:27]
    ds_read_b128 a[132:135], v18 offset:8192
    v_cvt_pk_bf16_f32 v113, v50, v51
    v_mfma_f32_16x16x32_bf16 a[28:31], a[172:175], v[204:207], a[28:31]
    s_waitcnt lgkmcnt(6)
    v_exp_f32 v58, v58
    v_mfma_f32_16x16x32_bf16 a[32:35], a[176:179], v[200:203], a[32:35]
    ds_read_b128 a[136:139], v18 offset:16384
    v_cvt_pk_bf16_f32 v116, v52, v53
    v_mfma_f32_16x16x32_bf16 a[36:39], a[176:179], v[204:207], a[36:39]
    v_exp_f32 v59, v59
    v_mfma_f32_16x16x32_bf16 a[40:43], a[180:183], v[200:203], a[40:43]
    ds_read_b128 a[140:143], v18 offset:24576
    v_cvt_pk_bf16_f32 v117, v54, v55
    v_mfma_f32_16x16x32_bf16 a[44:47], a[180:183], v[204:207], a[44:47]
    s_waitcnt lgkmcnt(4)
    v_exp_f32 v60, v60
    v_mfma_f32_16x16x32_bf16 a[48:51], a[184:187], v[200:203], a[48:51]
    ds_read_b128 a[144:147], v19 offset:0
    v_cvt_pk_bf16_f32 v114, v56, v57
    v_mfma_f32_16x16x32_bf16 a[52:55], a[184:187], v[204:207], a[52:55]
    v_exp_f32 v61, v61
    v_mfma_f32_16x16x32_bf16 a[56:59], a[188:191], v[200:203], a[56:59]
    ds_read_b128 a[148:151], v19 offset:8192
    v_cvt_pk_bf16_f32 v115, v58, v59
    v_mfma_f32_16x16x32_bf16 a[60:63], a[188:191], v[204:207], a[60:63]
    s_waitcnt lgkmcnt(4)
    v_exp_f32 v62, v62
    v_mfma_f32_16x16x32_bf16 v[80:83], a[128:131], a[64:67], v[244:247]
    s_mov_b32 m0, s26
    ds_read_b128 a[152:155], v19 offset:16384
    v_cvt_pk_bf16_f32 v118, v60, v61
    v_mfma_f32_16x16x32_bf16 v[84:87], a[128:131], a[68:71], v[248:251]
    s_add_u32 s30, s24, 4096
    v_exp_f32 v63, v63
    v_mfma_f32_16x16x32_bf16 v[88:91], a[132:135], a[64:67], v[244:247]
    s_add_u32 s25, s25, 32768
    ds_read_b128 a[156:159], v19 offset:24576
    v_cvt_pk_bf16_f32 v119, v62, v63
    v_mfma_f32_16x16x32_bf16 v[92:95], a[132:135], a[68:71], v[248:251]
    s_waitcnt lgkmcnt(4)
    buffer_load_dwordx4 v10, s[12:15], s24 offen offset:0 nt lds
    v_mfma_f32_16x16x32_bf16 v[96:99], a[136:139], a[64:67], v[244:247]
    s_cmp_ge_u32 s25, 163840
    ds_read_b128 a[160:163], v20 offset:0
    v_mfma_f32_16x16x32_bf16 v[100:103], a[136:139], a[68:71], v[248:251]
    s_cselect_b32 s25, 0, s25
    buffer_load_dwordx4 v11, s[12:15], s24 offen offset:1024 nt lds
    v_mfma_f32_16x16x32_bf16 v[104:107], a[140:143], a[64:67], v[244:247]
    ds_read_b128 a[164:167], v20 offset:8192
    v_add_u32 v30, s25, v22
    v_mfma_f32_16x16x32_bf16 v[108:111], a[140:143], a[68:71], v[248:251]
    s_waitcnt lgkmcnt(4)
    v_exp_f32 v64, v64
    v_mfma_f32_16x16x32_bf16 v[80:83], a[144:147], a[72:75], v[80:83]
    ds_read_b128 a[168:171], v20 offset:16384
    v_add_u32 v31, s25, v23
    v_mfma_f32_16x16x32_bf16 v[84:87], a[144:147], a[76:79], v[84:87]
    buffer_load_dwordx4 v12, s[12:15], s24 offen offset:2048 nt lds
    v_mfma_f32_16x16x32_bf16 v[88:91], a[148:151], a[72:75], v[88:91]
    ds_read_b128 a[172:175], v20 offset:24576
    v_add_u32 v32, s25, v24
    v_mfma_f32_16x16x32_bf16 v[92:95], a[148:151], a[76:79], v[92:95]
    s_waitcnt lgkmcnt(4)
    v_exp_f32 v65, v65
    v_mfma_f32_16x16x32_bf16 v[96:99], a[152:155], a[72:75], v[96:99]
    ds_read_b128 a[176:179], v21 offset:0
    v_add_u32 v33, s25, v25
    v_mfma_f32_16x16x32_bf16 v[100:103], a[152:155], a[76:79], v[100:103]
    buffer_load_dwordx4 v13, s[12:15], s24 offen offset:3072 nt lds
    v_mfma_f32_16x16x32_bf16 v[104:107], a[156:159], a[72:75], v[104:107]
    s_add_u32 m0, s26, 4096
    ds_read_b128 a[180:183], v21 offset:8192
    v_add_u32 v34, s25, v26
    v_mfma_f32_16x16x32_bf16 v[108:111], a[156:159], a[76:79], v[108:111]
    s_waitcnt lgkmcnt(4)
    v_exp_f32 v66, v66
    v_mfma_f32_16x16x32_bf16 v[80:83], a[160:163], a[80:83], v[80:83]
    s_add_u32 s24, s24, 32768
    ds_read_b128 a[184:187], v21 offset:16384
    v_add_u32 v35, s25, v27
    v_mfma_f32_16x16x32_bf16 v[84:87], a[160:163], a[84:87], v[84:87]
    buffer_load_dwordx4 v10, s[12:15], s30 offen offset:0 nt lds
    v_mfma_f32_16x16x32_bf16 v[88:91], a[164:167], a[80:83], v[88:91]
    ds_read_b128 a[188:191], v21 offset:24576
    v_add_u32 v36, s25, v28
    v_mfma_f32_16x16x32_bf16 v[92:95], a[164:167], a[84:87], v[92:95]
    s_waitcnt lgkmcnt(4)
    v_exp_f32 v67, v67
    v_mfma_f32_16x16x32_bf16 v[96:99], a[168:171], a[80:83], v[96:99]
    ds_read_b128 a[128:131], v18 offset:256
    v_add_u32 v37, s25, v29
    v_mfma_f32_16x16x32_bf16 v[100:103], a[168:171], a[84:87], v[100:103]
    buffer_load_dwordx4 v11, s[12:15], s30 offen offset:1024 nt lds
    v_mfma_f32_16x16x32_bf16 v[104:107], a[172:175], a[80:83], v[104:107]
    ds_read_b128 a[132:135], v18 offset:8448
    v_cvt_pk_bf16_f32 v120, v64, v65
    v_mfma_f32_16x16x32_bf16 v[108:111], a[172:175], a[84:87], v[108:111]
    s_waitcnt lgkmcnt(4)
    v_exp_f32 v68, v68
    v_mfma_f32_16x16x32_bf16 v[80:83], a[176:179], a[88:91], v[80:83]
    ds_read_b128 a[136:139], v18 offset:16640
    v_cvt_pk_bf16_f32 v121, v66, v67
    v_mfma_f32_16x16x32_bf16 v[84:87], a[176:179], a[92:95], v[84:87]
    buffer_load_dwordx4 v12, s[12:15], s30 offen offset:2048 nt lds
    v_mfma_f32_16x16x32_bf16 v[88:91], a[180:183], a[88:91], v[88:91]
    ds_read_b128 a[140:143], v18 offset:24832
    v_mfma_f32_16x16x32_bf16 v[92:95], a[180:183], a[92:95], v[92:95]
    s_waitcnt lgkmcnt(4)
    v_exp_f32 v69, v69
    v_mfma_f32_16x16x32_bf16 v[96:99], a[184:187], a[88:91], v[96:99]
    ds_read_b128 a[144:147], v19 offset:256
    v_cvt_pk_bf16_f32 v124, v68, v69
    v_mfma_f32_16x16x32_bf16 v[100:103], a[184:187], a[92:95], v[100:103]
    buffer_load_dwordx4 v13, s[12:15], s30 offen offset:3072 nt lds
    v_mfma_f32_16x16x32_bf16 v[104:107], a[188:191], a[88:91], v[104:107]
    s_add_u32 s26, s26, 32768
    ds_read_b128 a[148:151], v19 offset:8448
    v_mfma_f32_16x16x32_bf16 v[108:111], a[188:191], a[92:95], v[108:111]
    s_waitcnt lgkmcnt(4)
    v_exp_f32 v70, v70
    v_mfma_f32_16x16x32_bf16 v[80:83], a[128:131], a[96:99], v[80:83]
    s_cmp_ge_u32 s26, 163840
    ds_read_b128 a[152:155], v19 offset:16640
    v_mfma_f32_16x16x32_bf16 v[84:87], a[128:131], a[100:103], v[84:87]
    s_cselect_b32 s26, s34, s26
    v_exp_f32 v71, v71
    v_mfma_f32_16x16x32_bf16 v[88:91], a[132:135], a[96:99], v[88:91]
    ds_read_b128 a[156:159], v19 offset:24832
    v_cvt_pk_bf16_f32 v125, v70, v71
    v_mfma_f32_16x16x32_bf16 v[92:95], a[132:135], a[100:103], v[92:95]
    s_waitcnt lgkmcnt(4)
    v_exp_f32 v72, v72
    v_mfma_f32_16x16x32_bf16 v[96:99], a[136:139], a[96:99], v[96:99]
    ds_read_b128 a[160:163], v20 offset:256
    v_mfma_f32_16x16x32_bf16 v[100:103], a[136:139], a[100:103], v[100:103]
    v_exp_f32 v73, v73
    v_mfma_f32_16x16x32_bf16 v[104:107], a[140:143], a[96:99], v[104:107]
    ds_read_b128 a[164:167], v20 offset:8448
    v_cvt_pk_bf16_f32 v122, v72, v73
    v_mfma_f32_16x16x32_bf16 v[108:111], a[140:143], a[100:103], v[108:111]
    s_waitcnt lgkmcnt(4)
    v_exp_f32 v74, v74
    v_mfma_f32_16x16x32_bf16 v[80:83], a[144:147], a[104:107], v[80:83]
    ds_read_b128 a[168:171], v20 offset:16640
    v_mfma_f32_16x16x32_bf16 v[84:87], a[144:147], a[108:111], v[84:87]
    v_exp_f32 v75, v75
    v_mfma_f32_16x16x32_bf16 v[88:91], a[148:151], a[104:107], v[88:91]
    ds_read_b128 a[172:175], v20 offset:24832
    v_cvt_pk_bf16_f32 v123, v74, v75
    v_mfma_f32_16x16x32_bf16 v[92:95], a[148:151], a[108:111], v[92:95]
    s_waitcnt lgkmcnt(4)
    v_exp_f32 v76, v76
    v_mfma_f32_16x16x32_bf16 v[96:99], a[152:155], a[104:107], v[96:99]
    ds_read_b128 a[176:179], v21 offset:256
    v_mfma_f32_16x16x32_bf16 v[100:103], a[152:155], a[108:111], v[100:103]
    v_exp_f32 v77, v77
    v_mfma_f32_16x16x32_bf16 v[104:107], a[156:159], a[104:107], v[104:107]
    ds_read_b128 a[180:183], v21 offset:8448
    v_cvt_pk_bf16_f32 v126, v76, v77
    v_mfma_f32_16x16x32_bf16 v[108:111], a[156:159], a[108:111], v[108:111]
    s_waitcnt lgkmcnt(4)
    v_exp_f32 v78, v78
    v_mfma_f32_16x16x32_bf16 v[80:83], a[160:163], a[112:115], v[80:83]
    ds_read_b128 a[184:187], v21 offset:16640
    v_mfma_f32_16x16x32_bf16 v[84:87], a[160:163], a[116:119], v[84:87]
    v_exp_f32 v79, v79
    v_mfma_f32_16x16x32_bf16 v[88:91], a[164:167], a[112:115], v[88:91]
    ds_read_b128 a[188:191], v21 offset:24832
    v_cvt_pk_bf16_f32 v127, v78, v79
    v_mfma_f32_16x16x32_bf16 v[92:95], a[164:167], a[116:119], v[92:95]
    s_waitcnt lgkmcnt(4)
    v_mfma_f32_16x16x32_bf16 v[96:99], a[168:171], a[112:115], v[96:99]
    s_waitcnt vmcnt(16)
    s_barrier
    ds_read_b64_tr_b16 a[128:129], v30 offset:256
    ds_read_b64_tr_b16 a[130:131], v30 offset:8448
    v_mfma_f32_16x16x32_bf16 v[100:103], a[168:171], a[116:119], v[100:103]
    v_mfma_f32_16x16x32_bf16 v[104:107], a[172:175], a[112:115], v[104:107]
    ds_read_b64_tr_b16 a[132:133], v31 offset:256
    ds_read_b64_tr_b16 a[134:135], v31 offset:8448
    v_mfma_f32_16x16x32_bf16 v[108:111], a[172:175], a[116:119], v[108:111]
    s_waitcnt lgkmcnt(6)
    v_mfma_f32_16x16x32_bf16 v[80:83], a[176:179], a[120:123], v[80:83]
    ds_read_b64_tr_b16 a[136:137], v32 offset:256
    ds_read_b64_tr_b16 a[138:139], v32 offset:8448
    v_mfma_f32_16x16x32_bf16 v[84:87], a[176:179], a[124:127], v[84:87]
    v_mfma_f32_16x16x32_bf16 v[88:91], a[180:183], a[120:123], v[88:91]
    ds_read_b64_tr_b16 a[140:141], v33 offset:256
    ds_read_b64_tr_b16 a[142:143], v33 offset:8448
    v_mfma_f32_16x16x32_bf16 v[92:95], a[180:183], a[124:127], v[92:95]
    s_waitcnt lgkmcnt(8)
    v_mfma_f32_16x16x32_bf16 v[96:99], a[184:187], a[120:123], v[96:99]
    ds_read_b64_tr_b16 a[144:145], v34 offset:256
    ds_read_b64_tr_b16 a[146:147], v34 offset:8448
    v_mfma_f32_16x16x32_bf16 v[100:103], a[184:187], a[124:127], v[100:103]
    v_mfma_f32_16x16x32_bf16 v[104:107], a[188:191], a[120:123], v[104:107]
    ds_read_b64_tr_b16 a[148:149], v35 offset:256
    ds_read_b64_tr_b16 a[150:151], v35 offset:8448
    v_mfma_f32_16x16x32_bf16 v[108:111], a[188:191], a[124:127], v[108:111]
    s_sub_u32 s29, s29, 1
    s_cmp_lg_u32 s29, 0
    s_cbranch_scc1 L_loop
    v_readfirstlane_b32 s53, v240
    v_lshlrev_b32 v14, 7, v0
    v_and_b32 v15, 0x380, v14
    v_and_b32 v16, 0x80, v14
    v_lshrrev_b32 v14, 1, v0
    v_lshl_add_u32 v14, v14, 9, v16
    s_xor_b32 s53, s53, s27
    s_and_b32 s53, s53, 15
    s_cselect_b32 s54, s68, s72
    s_cselect_b32 s55, s92, s93
    buffer_load_dword v20, v14, s[16:19], s54 offen
    buffer_load_dword v21, v15, s[88:91], s55 offen
    s_waitcnt lgkmcnt(8)
    v_mfma_f32_16x16x32_bf16 v[128:131], a[128:131], v[112:115], v[128:131]
    s_add_u32 s25, s25, 32768
    ds_read_b64_tr_b16 a[152:153], v36 offset:256
    ds_read_b64_tr_b16 a[154:155], v36 offset:8448
    v_mfma_f32_16x16x32_bf16 v[132:135], a[128:131], v[116:119], v[132:135]
    s_cmp_ge_u32 s25, 163840
    v_mfma_f32_16x16x32_bf16 v[136:139], a[132:135], v[112:115], v[136:139]
    s_cselect_b32 s25, 0, s25
    ds_read_b64_tr_b16 a[156:157], v37 offset:256
    ds_read_b64_tr_b16 a[158:159], v37 offset:8448
    v_mfma_f32_16x16x32_bf16 v[140:143], a[132:135], v[116:119], v[140:143]
    s_waitcnt lgkmcnt(8)
    v_mfma_f32_16x16x32_bf16 v[144:147], a[136:139], v[112:115], v[144:147]
    s_add_u32 s25, s25, 32768
    ds_read_b64_tr_b16 a[160:161], v30 offset:16640
    ds_read_b64_tr_b16 a[162:163], v30 offset:24832
    v_mfma_f32_16x16x32_bf16 v[148:151], a[136:139], v[116:119], v[148:151]
    s_cmp_ge_u32 s25, 163840
    v_mfma_f32_16x16x32_bf16 v[152:155], a[140:143], v[112:115], v[152:155]
    s_cselect_b32 s25, 0, s25
    ds_read_b64_tr_b16 a[164:165], v31 offset:16640
    ds_read_b64_tr_b16 a[166:167], v31 offset:24832
    v_max3_f32 v42, v80, v81, v82
    v_max3_f32 v43, v84, v85, v86
    v_mfma_f32_16x16x32_bf16 v[156:159], a[140:143], v[116:119], v[156:159]
    s_waitcnt lgkmcnt(8)
    v_max3_f32 v42, v83, v88, v42
    v_max3_f32 v43, v87, v92, v43
    v_mfma_f32_16x16x32_bf16 v[160:163], a[144:147], v[112:115], v[160:163]
    ds_read_b64_tr_b16 a[168:169], v32 offset:16640
    ds_read_b64_tr_b16 a[170:171], v32 offset:24832
    v_max3_f32 v42, v89, v90, v42
    v_mfma_f32_16x16x32_bf16 v[164:167], a[144:147], v[116:119], v[164:167]
    v_max3_f32 v43, v93, v94, v43
    v_max3_f32 v42, v91, v96, v42
    v_mfma_f32_16x16x32_bf16 v[168:171], a[148:151], v[112:115], v[168:171]
    ds_read_b64_tr_b16 a[172:173], v33 offset:16640
    ds_read_b64_tr_b16 a[174:175], v33 offset:24832
    v_max3_f32 v43, v95, v100, v43
    v_mfma_f32_16x16x32_bf16 v[172:175], a[148:151], v[116:119], v[172:175]
    s_waitcnt lgkmcnt(8)
    v_max3_f32 v42, v97, v98, v42
    v_max3_f32 v43, v101, v102, v43
    v_mfma_f32_16x16x32_bf16 v[176:179], a[152:155], v[112:115], v[176:179]
    ds_read_b64_tr_b16 a[176:177], v34 offset:16640
    ds_read_b64_tr_b16 a[178:179], v34 offset:24832
    v_max3_f32 v42, v99, v104, v42
    v_mfma_f32_16x16x32_bf16 v[180:183], a[152:155], v[116:119], v[180:183]
    v_max3_f32 v43, v103, v108, v43
    v_max3_f32 v42, v105, v106, v42
    v_mfma_f32_16x16x32_bf16 v[184:187], a[156:159], v[112:115], v[184:187]
    ds_read_b64_tr_b16 a[180:181], v35 offset:16640
    ds_read_b64_tr_b16 a[182:183], v35 offset:24832
    v_max3_f32 v43, v109, v110, v43
    v_max_f32 v42, v107, v42
    v_mfma_f32_16x16x32_bf16 v[188:191], a[156:159], v[116:119], v[188:191]
    s_waitcnt lgkmcnt(8)
    v_max_f32 v43, v111, v43
    v_mfma_f32_16x16x32_bf16 v[128:131], a[160:163], v[120:123], v[128:131]
    ds_read_b64_tr_b16 a[184:185], v36 offset:16640
    ds_read_b64_tr_b16 a[186:187], v36 offset:24832
    v_max_f32 v44, v42, v43
    v_mfma_f32_16x16x32_bf16 v[132:135], a[160:163], v[124:127], v[132:135]
    v_cmp_lt_f32 vcc, s22, v44
    v_mfma_f32_16x16x32_bf16 v[136:139], a[164:167], v[120:123], v[136:139]
    s_cbranch_vccnz L_rare_6
L_back_6:
    ds_read_b64_tr_b16 a[188:189], v37 offset:16640
    ds_read_b64_tr_b16 a[190:191], v37 offset:24832
    v_mfma_f32_16x16x32_bf16 v[140:143], a[164:167], v[124:127], v[140:143]
    s_waitcnt lgkmcnt(8)
    v_exp_f32 v80, v80
    v_mfma_f32_16x16x32_bf16 v[144:147], a[168:171], v[120:123], v[144:147]
    v_exp_f32 v81, v81
    v_exp_f32 v82, v82
    v_mfma_f32_16x16x32_bf16 v[148:151], a[168:171], v[124:127], v[148:151]
    v_exp_f32 v83, v83
    v_cvt_pk_bf16_f32 v192, v80, v81
    v_mfma_f32_16x16x32_bf16 v[152:155], a[172:175], v[120:123], v[152:155]
    v_exp_f32 v84, v84
    v_mfma_f32_16x16x32_bf16 v[156:159], a[172:175], v[124:127], v[156:159]
    s_waitcnt lgkmcnt(4)
    v_exp_f32 v85, v85
    v_cvt_pk_bf16_f32 v193, v82, v83
    v_mfma_f32_16x16x32_bf16 v[160:163], a[176:179], v[120:123], v[160:163]
    ds_read_b64_tr_b16 a[128:129], v30 offset:0
    ds_read_b64_tr_b16 a[130:131], v30 offset:8192
    v_mfma_f32_16x16x32_bf16 v[164:167], a[176:179], v[124:127], v[164:167]
    v_exp_f32 v86, v86
    v_cvt_pk_bf16_f32 v196, v84, v85
    v_mfma_f32_16x16x32_bf16 v[168:171], a[180:183], v[120:123], v[168:171]
    ds_read_b64_tr_b16 a[132:133], v31 offset:0
    ds_read_b64_tr_b16 a[134:135], v31 offset:8192
    v_mfma_f32_16x16x32_bf16 v[172:175], a[180:183], v[124:127], v[172:175]
    s_waitcnt lgkmcnt(4)
    v_exp_f32 v87, v87
    v_mfma_f32_16x16x32_bf16 v[176:179], a[184:187], v[120:123], v[176:179]
    ds_read_b64_tr_b16 a[136:137], v32 offset:0
    ds_read_b64_tr_b16 a[138:139], v32 offset:8192
    v_cvt_pk_bf16_f32 v197, v86, v87
    v_mfma_f32_16x16x32_bf16 v[180:183], a[184:187], v[124:127], v[180:183]
    v_exp_f32 v88, v88
    v_mfma_f32_16x16x32_bf16 v[184:187], a[188:191], v[120:123], v[184:187]
    ds_read_b64_tr_b16 a[140:141], v33 offset:0
    ds_read_b64_tr_b16 a[142:143], v33 offset:8192
    v_exp_f32 v89, v89
    v_mfma_f32_16x16x32_bf16 v[188:191], a[188:191], v[124:127], v[188:191]
    v_exp_f32 v90, v90
    v_mfma_f32_16x16x32_bf16 a[196:199], a[192:195], v[112:115], a[196:199]
    ds_read_b64_tr_b16 a[144:145], v34 offset:0
    ds_read_b64_tr_b16 a[146:147], v34 offset:8192
    v_cvt_pk_bf16_f32 v194, v88, v89
    v_mfma_f32_16x16x32_bf16 a[200:203], a[192:195], v[116:119], a[200:203]
    v_exp_f32 v91, v91
    v_mfma_f32_16x16x32_bf16 a[196:199], a[192:195], v[120:123], a[196:199]
    ds_read_b64_tr_b16 a[148:149], v35 offset:0
    ds_read_b64_tr_b16 a[150:151], v35 offset:8192
    v_cvt_pk_bf16_f32 v195, v90, v91
    v_mfma_f32_16x16x32_bf16 a[200:203], a[192:195], v[124:127], a[200:203]
    s_waitcnt lgkmcnt(8)
    v_exp_f32 v92, v92
    v_mfma_f32_16x16x32_bf16 a[0:3], a[128:131], v[112:115], a[0:3]
    ds_read_b64_tr_b16 a[152:153], v36 offset:0
    ds_read_b64_tr_b16 a[154:155], v36 offset:8192
    v_mfma_f32_16x16x32_bf16 a[4:7], a[128:131], v[116:119], a[4:7]
    v_exp_f32 v93, v93
    v_exp_f32 v94, v94
    v_mfma_f32_16x16x32_bf16 a[8:11], a[132:135], v[112:115], a[8:11]
    ds_read_b64_tr_b16 a[156:157], v37 offset:0
    ds_read_b64_tr_b16 a[158:159], v37 offset:8192
    v_mfma_f32_16x16x32_bf16 a[12:15], a[132:135], v[116:119], a[12:15]
    s_waitcnt lgkmcnt(8)
    v_exp_f32 v95, v95
    v_cvt_pk_bf16_f32 v198, v92, v93
    v_mfma_f32_16x16x32_bf16 a[16:19], a[136:139], v[112:115], a[16:19]
    ds_read_b64_tr_b16 a[160:161], v30 offset:16384
    ds_read_b64_tr_b16 a[162:163], v30 offset:24576
    v_mfma_f32_16x16x32_bf16 a[20:23], a[136:139], v[116:119], a[20:23]
    v_exp_f32 v96, v96
    v_cvt_pk_bf16_f32 v199, v94, v95
    v_mfma_f32_16x16x32_bf16 a[24:27], a[140:143], v[112:115], a[24:27]
    ds_read_b64_tr_b16 a[164:165], v31 offset:16384
    ds_read_b64_tr_b16 a[166:167], v31 offset:24576
    v_mfma_f32_16x16x32_bf16 a[28:31], a[140:143], v[116:119], a[28:31]
    s_waitcnt lgkmcnt(8)
    v_exp_f32 v97, v97
    v_mfma_f32_16x16x32_bf16 a[32:35], a[144:147], v[112:115], a[32:35]
    ds_read_b64_tr_b16 a[168:169], v32 offset:16384
    ds_read_b64_tr_b16 a[170:171], v32 offset:24576
    v_cvt_pk_bf16_f32 v200, v96, v97
    v_mfma_f32_16x16x32_bf16 a[36:39], a[144:147], v[116:119], a[36:39]
    v_exp_f32 v98, v98
    v_mfma_f32_16x16x32_bf16 a[40:43], a[148:151], v[112:115], a[40:43]
    ds_read_b64_tr_b16 a[172:173], v33 offset:16384
    ds_read_b64_tr_b16 a[174:175], v33 offset:24576
    v_exp_f32 v99, v99
    v_mfma_f32_16x16x32_bf16 a[44:47], a[148:151], v[116:119], a[44:47]
    s_waitcnt lgkmcnt(8)
    v_exp_f32 v100, v100
    v_mfma_f32_16x16x32_bf16 a[48:51], a[152:155], v[112:115], a[48:51]
    ds_read_b64_tr_b16 a[176:177], v34 offset:16384
    ds_read_b64_tr_b16 a[178:179], v34 offset:24576
    v_cvt_pk_bf16_f32 v201, v98, v99
    v_mfma_f32_16x16x32_bf16 a[52:55], a[152:155], v[116:119], a[52:55]
    v_exp_f32 v101, v101
    v_mfma_f32_16x16x32_bf16 a[56:59], a[156:159], v[112:115], a[56:59]
    ds_read_b64_tr_b16 a[180:181], v35 offset:16384
    ds_read_b64_tr_b16 a[182:183], v35 offset:24576
    v_cvt_pk_bf16_f32 v204, v100, v101
    v_mfma_f32_16x16x32_bf16 a[60:63], a[156:159], v[116:119], a[60:63]
    s_waitcnt lgkmcnt(8)
    v_exp_f32 v102, v102
    v_mfma_f32_16x16x32_bf16 a[0:3], a[160:163], v[120:123], a[0:3]
    ds_read_b64_tr_b16 a[184:185], v36 offset:16384
    ds_read_b64_tr_b16 a[186:187], v36 offset:24576
    v_mfma_f32_16x16x32_bf16 a[4:7], a[160:163], v[124:127], a[4:7]
    v_exp_f32 v103, v103
    v_exp_f32 v104, v104
    v_mfma_f32_16x16x32_bf16 a[8:11], a[164:167], v[120:123], a[8:11]
    ds_read_b64_tr_b16 a[188:189], v37 offset:16384
    ds_read_b64_tr_b16 a[190:191], v37 offset:24576
    v_mfma_f32_16x16x32_bf16 a[12:15], a[164:167], v[124:127], a[12:15]
    s_waitcnt lgkmcnt(8)
    v_cvt_pk_bf16_f32 v205, v102, v103
    v_add_u32 v30, s25, v22
    v_add_u32 v31, s25, v23
    v_add_u32 v32, s25, v24
    v_add_u32 v33, s25, v25
    v_add_u32 v34, s25, v26
    v_add_u32 v35, s25, v27
    v_add_u32 v36, s25, v28
    v_add_u32 v37, s25, v29
    v_mfma_f32_16x16x32_bf16 a[16:19], a[168:171], v[120:123], a[16:19]
    s_waitcnt vmcnt(2)
    s_barrier
    ds_read_b64_tr_b16 a[128:129], v30 offset:256
    ds_read_b64_tr_b16 a[130:131], v30 offset:8448
    v_mfma_f32_16x16x32_bf16 a[20:23], a[168:171], v[124:127], a[20:23]
    v_exp_f32 v105, v105
    v_mfma_f32_16x16x32_bf16 a[24:27], a[172:175], v[120:123], a[24:27]
    ds_read_b64_tr_b16 a[132:133], v30 offset:16640
    ds_read_b64_tr_b16 a[134:135], v30 offset:24832
    v_cvt_pk_bf16_f32 v202, v104, v105
    v_mfma_f32_16x16x32_bf16 a[28:31], a[172:175], v[124:127], a[28:31]
    s_waitcnt lgkmcnt(8)
    v_exp_f32 v106, v106
    v_mfma_f32_16x16x32_bf16 a[32:35], a[176:179], v[120:123], a[32:35]
    ds_read_b64_tr_b16 a[136:137], v31 offset:256
    ds_read_b64_tr_b16 a[138:139], v31 offset:8448
    v_mfma_f32_16x16x32_bf16 a[36:39], a[176:179], v[124:127], a[36:39]
    v_exp_f32 v107, v107
    v_exp_f32 v108, v108
    v_mfma_f32_16x16x32_bf16 a[40:43], a[180:183], v[120:123], a[40:43]
    ds_read_b64_tr_b16 a[140:141], v31 offset:16640
    ds_read_b64_tr_b16 a[142:143], v31 offset:24832
    v_cvt_pk_bf16_f32 v203, v106, v107
    v_mfma_f32_16x16x32_bf16 a[44:47], a[180:183], v[124:127], a[44:47]
    s_waitcnt lgkmcnt(8)
    v_exp_f32 v109, v109
    v_mfma_f32_16x16x32_bf16 a[48:51], a[184:187], v[120:123], a[48:51]
    ds_read_b64_tr_b16 a[144:145], v32 offset:256
    ds_read_b64_tr_b16 a[146:147], v32 offset:8448
    v_cvt_pk_bf16_f32 v206, v108, v109
    v_mfma_f32_16x16x32_bf16 a[52:55], a[184:187], v[124:127], a[52:55]
    v_exp_f32 v110, v110
    v_mfma_f32_16x16x32_bf16 a[56:59], a[188:191], v[120:123], a[56:59]
    ds_read_b64_tr_b16 a[148:149], v32 offset:16640
    ds_read_b64_tr_b16 a[150:151], v32 offset:24832
    v_mfma_f32_16x16x32_bf16 a[60:63], a[188:191], v[124:127], a[60:63]
    v_exp_f32 v111, v111
    s_nop 0
    v_cvt_pk_bf16_f32 v207, v110, v111
    s_cmp_lg_u32 s53, 0
    s_cbranch_scc1 L_far
    s_waitcnt lgkmcnt(8)
    v_mfma_f32_16x16x32_bf16 v[128:131], a[128:131], v[192:195], v[128:131]
    ds_read_b64_tr_b16 a[152:153], v33 offset:256
    ds_read_b64_tr_b16 a[154:155], v33 offset:8448
    v_mfma_f32_16x16x32_bf16 v[132:135], a[128:131], v[196:199], v[132:135]
    v_and_b32 v14, 7, v0
    v_lshlrev_b32 v14, 9, v14
    v_mfma_f32_16x16x32_bf16 v[128:131], a[132:135], v[200:203], v[128:131]
    ds_read_b64_tr_b16 a[156:157], v33 offset:16640
    ds_read_b64_tr_b16 a[158:159], v33 offset:24832
    v_mfma_f32_16x16x32_bf16 v[132:135], a[132:135], v[204:207], v[132:135]
    s_waitcnt lgkmcnt(8)
    v_bfe_u32 v15, v0, 4, 1
    v_lshl_add_u32 v14, v15, 5, v14
    v_mfma_f32_16x16x32_bf16 v[136:139], a[136:139], v[192:195], v[136:139]
    v_mfma_f32_16x16x32_bf16 v[140:143], a[136:139], v[196:199], v[140:143]
    v_lshrrev_b32 v15, 5, v0
    v_lshl_add_u32 v14, v15, 4, v14
    v_mfma_f32_16x16x32_bf16 v[136:139], a[140:143], v[200:203], v[136:139]
    v_mfma_f32_16x16x32_bf16 v[140:143], a[140:143], v[204:207], v[140:143]
    s_waitcnt lgkmcnt(4)
    v_bfe_u32 v15, v0, 3, 1
    v_lshl_add_u32 v14, v15, 6, v14
    v_cvt_pk_bf16_f32 v48, v128, v129
    v_cvt_pk_bf16_f32 v49, v130, v131
    v_mfma_f32_16x16x32_bf16 v[144:147], a[144:147], v[192:195], v[144:147]
    ds_read_b64_tr_b16 a[160:161], v34 offset:256
    ds_read_b64_tr_b16 a[162:163], v34 offset:8448
    v_cvt_pk_bf16_f32 v50, v132, v133
    v_mfma_f32_16x16x32_bf16 v[148:151], a[144:147], v[196:199], v[148:151]
    v_mov_b32 v18, v240
    s_mov_b32 s55, 1000000
    v_cvt_pk_bf16_f32 v51, v134, v135
    buffer_store_dwordx4 v[48:51], v1, s[16:19], s68 offen offset:0
    v_mfma_f32_16x16x32_bf16 v[144:147], a[148:151], v[200:203], v[144:147]
    ds_read_b64_tr_b16 a[164:165], v34 offset:16640
    ds_read_b64_tr_b16 a[166:167], v34 offset:24832
    v_mfma_f32_16x16x32_bf16 v[148:151], a[148:151], v[204:207], v[148:151]
    s_waitcnt lgkmcnt(4)
    v_cvt_pk_bf16_f32 v52, v136, v137
    v_cvt_pk_bf16_f32 v53, v138, v139
    v_mfma_f32_16x16x32_bf16 v[152:155], a[152:155], v[192:195], v[152:155]
    ds_read_b64_tr_b16 a[168:169], v35 offset:256
    ds_read_b64_tr_b16 a[170:171], v35 offset:8448
    v_cvt_pk_bf16_f32 v54, v140, v141
    v_mfma_f32_16x16x32_bf16 v[156:159], a[152:155], v[196:199], v[156:159]
    v_cvt_pk_bf16_f32 v55, v142, v143
    buffer_store_dwordx4 v[52:55], v1, s[16:19], s68 offen offset:2048
    v_mfma_f32_16x16x32_bf16 v[152:155], a[156:159], v[200:203], v[152:155]
    ds_read_b64_tr_b16 a[172:173], v35 offset:16640
    ds_read_b64_tr_b16 a[174:175], v35 offset:24832
    v_add3_u32 v18, v52, v53, v18
    v_add3_u32 v18, v54, v55, v18
    v_mfma_f32_16x16x32_bf16 v[156:159], a[156:159], v[204:207], v[156:159]
    v_cvt_pk_bf16_f32 v56, v144, v145
    v_cvt_pk_bf16_f32 v57, v146, v147
    v_mfma_f32_16x16x32_bf16 a[196:199], a[192:195], v[192:195], a[196:199]
    ds_read_b64_tr_b16 a[176:177], v36 offset:256
    ds_read_b64_tr_b16 a[178:179], v36 offset:8448
    v_cvt_pk_bf16_f32 v58, v148, v149
    v_mfma_f32_16x16x32_bf16 a[200:203], a[192:195], v[196:199], a[200:203]
    v_cvt_pk_bf16_f32 v59, v150, v151
    buffer_store_dwordx4 v[56:59], v1, s[16:19], s69 offen offset:0
    v_mfma_f32_16x16x32_bf16 a[196:199], a[192:195], v[200:203], a[196:199]
    ds_read_b64_tr_b16 a[180:181], v36 offset:16640
    ds_read_b64_tr_b16 a[182:183], v36 offset:24832
    v_add3_u32 v18, v56, v57, v18
    v_add3_u32 v18, v58, v59, v18
    v_mfma_f32_16x16x32_bf16 a[200:203], a[192:195], v[204:207], a[200:203]
    s_waitcnt lgkmcnt(8)
    v_cvt_pk_bf16_f32 v60, v152, v153
    v_cvt_pk_bf16_f32 v61, v154, v155
    v_mfma_f32_16x16x32_bf16 v[160:163], a[160:163], v[192:195], v[160:163]
    ds_read_b64_tr_b16 a[184:185], v37 offset:256
    ds_read_b64_tr_b16 a[186:187], v37 offset:8448
    v_cvt_pk_bf16_f32 v62, v156, v157
    v_mfma_f32_16x16x32_bf16 v[164:167], a[160:163], v[196:199], v[164:167]
    v_cvt_pk_bf16_f32 v63, v158, v159
    buffer_store_dwordx4 v[60:63], v1, s[16:19], s69 offen offset:2048
    v_mfma_f32_16x16x32_bf16 v[160:163], a[164:167], v[200:203], v[160:163]
    ds_read_b64_tr_b16 a[188:189], v37 offset:16640
    ds_read_b64_tr_b16 a[190:191], v37 offset:24832
    v_add3_u32 v18, v60, v61, v18
    v_add3_u32 v18, v62, v63, v18
    v_mfma_f32_16x16x32_bf16 v[164:167], a[164:167], v[204:207], v[164:167]
    s_waitcnt lgkmcnt(8)
    v_mfma_f32_16x16x32_bf16 v[168:171], a[168:171], v[192:195], v[168:171]
    ds_read_b64_tr_b16 a[128:129], v30 offset:0
    ds_read_b64_tr_b16 a[130:131], v30 offset:8192
    v_mfma_f32_16x16x32_bf16 v[172:175], a[168:171], v[196:199], v[172:175]
    v_accvgpr_read_b32 v40, a196
    v_accvgpr_read_b32 v41, a200
    v_mfma_f32_16x16x32_bf16 v[168:171], a[172:175], v[200:203], v[168:171]
    ds_read_b64_tr_b16 a[132:133], v30 offset:16384
    ds_read_b64_tr_b16 a[134:135], v30 offset:24576
    v_mfma_f32_16x16x32_bf16 v[172:175], a[172:175], v[204:207], v[172:175]
    s_waitcnt lgkmcnt(8)
    v_cndmask_b32 v16, v38, v39, s[66:67]
    v_cndmask_b32 v17, v40, v41, s[66:67]
    v_cvt_pk_bf16_f32 v64, v160, v161
    v_cvt_pk_bf16_f32 v65, v162, v163
    v_mfma_f32_16x16x32_bf16 v[176:179], a[176:179], v[192:195], v[176:179]
    ds_read_b64_tr_b16 a[136:137], v31 offset:0
    ds_read_b64_tr_b16 a[138:139], v31 offset:8192
    v_cvt_pk_bf16_f32 v66, v164, v165
    v_mfma_f32_16x16x32_bf16 v[180:183], a[176:179], v[196:199], v[180:183]
    v_add3_u32 v18, v16, v17, v18
    v_cvt_pk_bf16_f32 v67, v166, v167
    buffer_store_dwordx4 v[64:67], v1, s[16:19], s70 offen offset:0
    v_mfma_f32_16x16x32_bf16 v[176:179], a[180:183], v[200:203], v[176:179]
    ds_read_b64_tr_b16 a[140:141], v31 offset:16384
    ds_read_b64_tr_b16 a[142:143], v31 offset:24576
    v_add3_u32 v18, v64, v65, v18
    v_add3_u32 v18, v66, v67, v18
    v_add3_u32 v18, v48, v49, v18
    v_add3_u32 v18, v50, v51, v18
    v_mfma_f32_16x16x32_bf16 v[180:183], a[180:183], v[204:207], v[180:183]
    s_waitcnt lgkmcnt(8)
    v_cvt_pk_bf16_f32 v68, v168, v169
    v_cvt_pk_bf16_f32 v69, v170, v171
    v_mfma_f32_16x16x32_bf16 v[184:187], a[184:187], v[192:195], v[184:187]
    ds_read_b64_tr_b16 a[144:145], v32 offset:0
    ds_read_b64_tr_b16 a[146:147], v32 offset:8192
    v_cvt_pk_bf16_f32 v70, v172, v173
    v_mfma_f32_16x16x32_bf16 v[188:191], a[184:187], v[196:199], v[188:191]
    v_cvt_pk_bf16_f32 v71, v174, v175
    buffer_store_dwordx4 v[68:71], v1, s[16:19], s70 offen offset:2048
    v_mfma_f32_16x16x32_bf16 v[184:187], a[188:191], v[200:203], v[184:187]
    ds_read_b64_tr_b16 a[148:149], v32 offset:16384
    ds_read_b64_tr_b16 a[150:151], v32 offset:24576
    v_add3_u32 v18, v68, v69, v18
    v_add3_u32 v18, v70, v71, v18
    v_mfma_f32_16x16x32_bf16 v[188:191], a[188:191], v[204:207], v[188:191]
    s_waitcnt lgkmcnt(8)
    v_cvt_pk_bf16_f32 v72, v176, v177
    v_cvt_pk_bf16_f32 v73, v178, v179
    v_mfma_f32_16x16x32_bf16 a[0:3], a[128:131], v[192:195], a[0:3]
    ds_read_b64_tr_b16 a[152:153], v33 offset:0
    ds_read_b64_tr_b16 a[154:155], v33 offset:8192
    v_cvt_pk_bf16_f32 v74, v180, v181
    v_mfma_f32_16x16x32_bf16 a[4:7], a[128:131], v[196:199], a[4:7]
    v_cvt_pk_bf16_f32 v75, v182, v183
    buffer_store_dwordx4 v[72:75], v1, s[16:19], s71 offen offset:0
    v_mfma_f32_16x16x32_bf16 a[0:3], a[132:135], v[200:203], a[0:3]
    ds_read_b64_tr_b16 a[156:157], v33 offset:16384
    ds_read_b64_tr_b16 a[158:159], v33 offset:24576
    v_add3_u32 v18, v72, v73, v18
    v_add3_u32 v18, v74, v75, v18
    v_mfma_f32_16x16x32_bf16 a[4:7], a[132:135], v[204:207], a[4:7]
    s_waitcnt lgkmcnt(8)
    v_cvt_pk_bf16_f32 v76, v184, v185
    v_cvt_pk_bf16_f32 v77, v186, v187
    v_mfma_f32_16x16x32_bf16 a[8:11], a[136:139], v[192:195], a[8:11]
    ds_read_b64_tr_b16 a[160:161], v34 offset:0
    ds_read_b64_tr_b16 a[162:163], v34 offset:8192
    v_cvt_pk_bf16_f32 v78, v188, v189
    v_mfma_f32_16x16x32_bf16 a[12:15], a[136:139], v[196:199], a[12:15]
    v_cvt_pk_bf16_f32 v79, v190, v191
    buffer_store_dwordx4 v[76:79], v1, s[16:19], s71 offen offset:2048
    v_mfma_f32_16x16x32_bf16 a[8:11], a[140:143], v[200:203], a[8:11]
    ds_read_b64_tr_b16 a[164:165], v34 offset:16384
    ds_read_b64_tr_b16 a[166:167], v34 offset:24576
    v_add3_u32 v18, v76, v77, v18
    v_add3_u32 v18, v78, v79, v18
    v_mfma_f32_16x16x32_bf16 a[12:15], a[140:143], v[204:207], a[12:15]
    s_waitcnt lgkmcnt(8)
    buffer_store_dwordx4 v[16:19], v241, s[88:91], s92 offen
    v_mfma_f32_16x16x32_bf16 a[16:19], a[144:147], v[192:195], a[16:19]
    ds_read_b64_tr_b16 a[168:169], v35 offset:0
    ds_read_b64_tr_b16 a[170:171], v35 offset:8192
    v_mfma_f32_16x16x32_bf16 a[20:23], a[144:147], v[196:199], a[20:23]
    v_accvgpr_read_b32 v128, a0
    v_accvgpr_read_b32 v129, a1
    v_mfma_f32_16x16x32_bf16 a[16:19], a[148:151], v[200:203], a[16:19]
    ds_read_b64_tr_b16 a[172:173], v35 offset:16384
    ds_read_b64_tr_b16 a[174:175], v35 offset:24576
    v_mfma_f32_16x16x32_bf16 a[20:23], a[148:151], v[204:207], a[20:23]
    s_waitcnt lgkmcnt(8)
    v_accvgpr_read_b32 v130, a2
    v_accvgpr_read_b32 v131, a3
    v_mfma_f32_16x16x32_bf16 a[24:27], a[152:155], v[192:195], a[24:27]
    ds_read_b64_tr_b16 a[176:177], v36 offset:0
    ds_read_b64_tr_b16 a[178:179], v36 offset:8192
    v_mfma_f32_16x16x32_bf16 a[28:31], a[152:155], v[196:199], a[28:31]
    v_accvgpr_read_b32 v132, a4
    v_accvgpr_read_b32 v133, a5
    v_accvgpr_read_b32 v136, a8
    v_accvgpr_read_b32 v137, a9
    v_mfma_f32_16x16x32_bf16 a[24:27], a[156:159], v[200:203], a[24:27]
    ds_read_b64_tr_b16 a[180:181], v36 offset:16384
    ds_read_b64_tr_b16 a[182:183], v36 offset:24576
    buffer_load_dwordx4 v[80:83], v1, s[16:19], s72 offen offset:0 sc1
    v_mfma_f32_16x16x32_bf16 a[28:31], a[156:159], v[204:207], a[28:31]
    s_waitcnt lgkmcnt(8)
    buffer_load_dwordx4 v[84:87], v1, s[16:19], s72 offen offset:2048 sc1
    v_accvgpr_read_b32 v134, a6
    v_accvgpr_read_b32 v135, a7
    v_accvgpr_read_b32 v138, a10
    v_accvgpr_read_b32 v139, a11
    v_mfma_f32_16x16x32_bf16 a[32:35], a[160:163], v[192:195], a[32:35]
    ds_read_b64_tr_b16 a[184:185], v37 offset:0
    ds_read_b64_tr_b16 a[186:187], v37 offset:8192
    buffer_load_dwordx4 v[88:91], v1, s[16:19], s73 offen offset:0 sc1
    v_mfma_f32_16x16x32_bf16 a[36:39], a[160:163], v[196:199], a[36:39]
    buffer_load_dwordx4 v[92:95], v1, s[16:19], s73 offen offset:2048 sc1
    v_accvgpr_read_b32 v140, a12
    v_accvgpr_read_b32 v141, a13
    v_accvgpr_read_b32 v144, a16
    v_accvgpr_read_b32 v145, a17
    v_mfma_f32_16x16x32_bf16 a[32:35], a[164:167], v[200:203], a[32:35]
    ds_read_b64_tr_b16 a[188:189], v37 offset:16384
    ds_read_b64_tr_b16 a[190:191], v37 offset:24576
    buffer_load_dwordx4 v[96:99], v1, s[16:19], s74 offen offset:0 sc1
    v_mfma_f32_16x16x32_bf16 a[36:39], a[164:167], v[204:207], a[36:39]
    s_waitcnt lgkmcnt(8)
    buffer_load_dwordx4 v[100:103], v1, s[16:19], s74 offen offset:2048 sc1
    v_accvgpr_read_b32 v142, a14
    v_accvgpr_read_b32 v143, a15
    v_accvgpr_read_b32 v146, a18
    v_accvgpr_read_b32 v147, a19
    v_mfma_f32_16x16x32_bf16 a[40:43], a[168:171], v[192:195], a[40:43]
    buffer_load_dwordx4 v[104:107], v1, s[16:19], s75 offen offset:0 sc1
    v_mfma_f32_16x16x32_bf16 a[44:47], a[168:171], v[196:199], a[44:47]
    buffer_load_dwordx4 v[108:111], v1, s[16:19], s75 offen offset:2048 sc1
    v_accvgpr_read_b32 v148, a20
    v_accvgpr_read_b32 v149, a21
    v_accvgpr_read_b32 v152, a24
    v_accvgpr_read_b32 v153, a25
    v_mfma_f32_16x16x32_bf16 a[40:43], a[172:175], v[200:203], a[40:43]
    buffer_load_dwordx4 v[44:47], v241, s[88:91], s93 offen sc1
    v_mfma_f32_16x16x32_bf16 a[44:47], a[172:175], v[204:207], a[44:47]
    s_waitcnt lgkmcnt(4)
    v_accvgpr_read_b32 v150, a22
    v_accvgpr_read_b32 v151, a23
    v_accvgpr_read_b32 v154, a26
    v_accvgpr_read_b32 v155, a27
    v_mfma_f32_16x16x32_bf16 a[48:51], a[176:179], v[192:195], a[48:51]
    v_mfma_f32_16x16x32_bf16 a[52:55], a[176:179], v[196:199], a[52:55]
    v_accvgpr_read_b32 v156, a28
    v_accvgpr_read_b32 v157, a29
    v_accvgpr_read_b32 v160, a32
    v_accvgpr_read_b32 v161, a33
    v_mfma_f32_16x16x32_bf16 a[48:51], a[180:183], v[200:203], a[48:51]
    v_mfma_f32_16x16x32_bf16 a[52:55], a[180:183], v[204:207], a[52:55]
    s_waitcnt lgkmcnt(0)
    v_accvgpr_read_b32 v158, a30
    v_accvgpr_read_b32 v159, a31
    v_accvgpr_read_b32 v162, a34
    v_accvgpr_read_b32 v163, a35
    v_mfma_f32_16x16x32_bf16 a[56:59], a[184:187], v[192:195], a[56:59]
    v_mfma_f32_16x16x32_bf16 a[60:63], a[184:187], v[196:199], a[60:63]
    v_accvgpr_read_b32 v164, a36
    v_accvgpr_read_b32 v165, a37
    v_mfma_f32_16x16x32_bf16 a[56:59], a[188:191], v[200:203], a[56:59]
    v_mfma_f32_16x16x32_bf16 a[60:63], a[188:191], v[204:207], a[60:63]
    v_accvgpr_read_b32 v166, a38
    v_accvgpr_read_b32 v167, a39
    s_nop 7
    v_accvgpr_read_b32 v168, a40
    v_accvgpr_read_b32 v169, a41
    v_accvgpr_read_b32 v170, a42
    v_accvgpr_read_b32 v171, a43
    v_accvgpr_read_b32 v172, a44
    v_accvgpr_read_b32 v173, a45
    v_accvgpr_read_b32 v174, a46
    v_accvgpr_read_b32 v175, a47
    v_accvgpr_read_b32 v176, a48
    v_accvgpr_read_b32 v177, a49
    v_accvgpr_read_b32 v178, a50
    v_accvgpr_read_b32 v179, a51
    v_accvgpr_read_b32 v180, a52
    v_accvgpr_read_b32 v181, a53
    v_accvgpr_read_b32 v182, a54
    v_accvgpr_read_b32 v183, a55
    v_accvgpr_read_b32 v184, a56
    v_accvgpr_read_b32 v185, a57
    v_accvgpr_read_b32 v186, a58
    v_accvgpr_read_b32 v187, a59
    v_accvgpr_read_b32 v188, a60
    v_accvgpr_read_b32 v189, a61
    v_accvgpr_read_b32 v190, a62
    v_accvgpr_read_b32 v191, a63
L_retry_n:
    s_waitcnt vmcnt(0)
    v_add3_u32 v42, v44, v45, s27
    v_add3_u32 v43, v80, v81, v82
    v_add_u32 v42, v42, v83
    v_add3_u32 v43, v84, v85, v43
    v_add3_u32 v42, v86, v87, v42
    v_add3_u32 v43, v88, v89, v43
    v_add3_u32 v42, v90, v91, v42
    v_add3_u32 v43, v92, v93, v43
    v_add3_u32 v42, v94, v95, v42
    v_add3_u32 v43, v96, v97, v43
    v_add3_u32 v42, v98, v99, v42
    v_add3_u32 v43, v100, v101, v43
    v_add3_u32 v42, v102, v103, v42
    v_add3_u32 v43, v104, v105, v43
    v_add3_u32 v42, v106, v107, v42
    v_add3_u32 v43, v108, v109, v43
    v_add3_u32 v42, v110, v111, v42
    v_add_u32 v42, v42, v43
    v_cmp_ne_u32 vcc, v46, v42
    s_cbranch_vccz L_got_n
    buffer_load_dword v15, off, s[88:91], s95 sc1
    buffer_load_dwordx4 v[80:83], v1, s[16:19], s72 offen offset:0 sc1
    buffer_load_dwordx4 v[84:87], v1, s[16:19], s72 offen offset:2048 sc1
    buffer_load_dwordx4 v[88:91], v1, s[16:19], s73 offen offset:0 sc1
    buffer_load_dwordx4 v[92:95], v1, s[16:19], s73 offen offset:2048 sc1
    buffer_load_dwordx4 v[96:99], v1, s[16:19], s74 offen offset:0 sc1
    buffer_load_dwordx4 v[100:103], v1, s[16:19], s74 offen offset:2048 sc1
    buffer_load_dwordx4 v[104:107], v1, s[16:19], s75 offen offset:0 sc1
    buffer_load_dwordx4 v[108:111], v1, s[16:19], s75 offen offset:2048 sc1
    buffer_load_dwordx4 v[44:47], v241, s[88:91], s93 offen sc1
    s_waitcnt vmcnt(9)
    v_cmp_ne_u32 vcc, v15, v240
    s_cbranch_vccz L_same_n
    v_sub_u32 v18, v18, v240
    v_add_u32 v18, v18, v15
    v_mov_b32 v240, v15
    buffer_store_dwordx4 v[48:51], v1, s[16:19], s68 offen offset:0 sc1
    buffer_store_dwordx4 v[52:55], v1, s[16:19], s68 offen offset:2048 sc1
    buffer_store_dwordx4 v[56:59], v1, s[16:19], s69 offen offset:0 sc1
    buffer_store_dwordx4 v[60:63], v1, s[16:19], s69 offen offset:2048 sc1
    buffer_store_dwordx4 v[64:67], v1, s[16:19], s70 offen offset:0 sc1
    buffer_store_dwordx4 v[68:71], v1, s[16:19], s70 offen offset:2048 sc1
    buffer_store_dwordx4 v[72:75], v1, s[16:19], s71 offen offset:0 sc1
    buffer_store_dwordx4 v[76:79], v1, s[16:19], s71 offen offset:2048 sc1
    buffer_store_dwordx4 v[16:19], v241, s[88:91], s92 offen sc1
L_same_n:
    s_sub_u32 s55, s55, 1
    s_cmp_lg_u32 s55, 0
    s_cbranch_scc1 L_retry_n
    s_waitcnt vmcnt(0)
L_got_n:
    v_mov_b32 v46, v44
    v_mov_b32 v47, v45
    s_nop 1
    v_permlane16_swap_b32 v44, v46
    v_permlane16_swap_b32 v45, v47
    s_nop 0
    v_max_f32 v42, v38, v44
    v_max_f32 v43, v39, v46
    v_sub_f32 v16, v38, v42
    v_sub_f32 v17, v39, v43
    v_sub_f32 v18, v44, v42
    v_sub_f32 v19, v46, v43
    v_exp_f32 v16, v16
    v_exp_f32 v17, v17
    v_exp_f32 v18, v18
    v_exp_f32 v19, v19
    v_mul_f32 v42, v16, v40
    v_mul_f32 v43, v17, v41
    v_fmac_f32 v42, v18, v45
    v_fmac_f32 v43, v19, v47
    v_rcp_f32 v42, v42
    v_rcp_f32 v43, v43
    s_nop 0
    v_mul_f32 v16, v16, v42
    v_mul_f32 v17, v17, v43
    v_mul_f32 v18, v18, v42
    v_mul_f32 v19, v19, v43
    v_lshlrev_b32 v48, 16, v80
    v_and_b32 v49, 0xffff0000, v80
    v_lshlrev_b32 v50, 16, v81
    v_and_b32 v51, 0xffff0000, v81
    v_lshlrev_b32 v52, 16, v84
    v_and_b32 v53, 0xffff0000, v84
    v_lshlrev_b32 v54, 16, v85
    v_and_b32 v55, 0xffff0000, v85
    v_pk_mul_f32 v[128:129], v[128:129], v[16:17] op_sel:[0,0] op_sel_hi:[1,0]
    v_pk_mul_f32 v[130:131], v[130:131], v[16:17] op_sel:[0,0] op_sel_hi:[1,0]
    v_pk_mul_f32 v[136:137], v[136:137], v[16:17] op_sel:[0,0] op_sel_hi:[1,0]
    v_pk_mul_f32 v[138:139], v[138:139], v[16:17] op_sel:[0,0] op_sel_hi:[1,0]
    v_pk_fma_f32 v[128:129], v[48:49], v[18:19], v[128:129] op_sel:[0,0,0] op_sel_hi:[1,0,1]
    v_pk_fma_f32 v[130:131], v[50:51], v[18:19], v[130:131] op_sel:[0,0,0] op_sel_hi:[1,0,1]
    v_pk_fma_f32 v[136:137], v[52:53], v[18:19], v[136:137] op_sel:[0,0,0] op_sel_hi:[1,0,1]
    v_pk_fma_f32 v[138:139], v[54:55], v[18:19], v[138:139] op_sel:[0,0,0] op_sel_hi:[1,0,1]
    v_cvt_pk_bf16_f32 v56, v128, v129
    v_cvt_pk_bf16_f32 v57, v130, v131
    v_cvt_pk_bf16_f32 v58, v136, v137
    v_cvt_pk_bf16_f32 v59, v138, v139
    v_lshlrev_b32 v112, 16, v88
    v_and_b32 v113, 0xffff0000, v88
    v_lshlrev_b32 v114, 16, v89
    v_and_b32 v115, 0xffff0000, v89
    v_lshlrev_b32 v116, 16, v92
    v_and_b32 v117, 0xffff0000, v92
    v_lshlrev_b32 v118, 16, v93
    v_and_b32 v119, 0xffff0000, v93
    v_pk_mul_f32 v[144:145], v[144:145], v[16:17] op_sel:[0,0] op_sel_hi:[1,0]
    v_pk_mul_f32 v[146:147], v[146:147], v[16:17] op_sel:[0,0] op_sel_hi:[1,0]
    v_pk_mul_f32 v[152:153], v[152:153], v[16:17] op_sel:[0,0] op_sel_hi:[1,0]
    v_pk_mul_f32 v[154:155], v[154:155], v[16:17] op_sel:[0,0] op_sel_hi:[1,0]
    v_pk_fma_f32 v[144:145], v[112:113], v[18:19], v[144:145] op_sel:[0,0,0] op_sel_hi:[1,0,1]
    v_pk_fma_f32 v[146:147], v[114:115], v[18:19], v[146:147] op_sel:[0,0,0] op_sel_hi:[1,0,1]
    v_pk_fma_f32 v[152:153], v[116:117], v[18:19], v[152:153] op_sel:[0,0,0] op_sel_hi:[1,0,1]
    v_pk_fma_f32 v[154:155], v[118:119], v[18:19], v[154:155] op_sel:[0,0,0] op_sel_hi:[1,0,1]
    v_cvt_pk_bf16_f32 v60, v144, v145
    v_cvt_pk_bf16_f32 v61, v146, v147
    v_cvt_pk_bf16_f32 v62, v152, v153
    v_cvt_pk_bf16_f32 v63, v154, v155
    v_permlane16_swap_b32 v56, v58
    v_permlane16_swap_b32 v57, v59
    s_nop 0
    v_permlane16_swap_b32 v60, v62
    v_permlane16_swap_b32 v61, v63
    v_mov_b32 v64, v56
    v_mov_b32 v65, v57
    v_mov_b32 v66, v58
    v_mov_b32 v67, v59
    v_mov_b32_dpp v56, v60 row_ror:8 row_mask:0xf bank_mask:0xc
    v_mov_b32_dpp v57, v61 row_ror:8 row_mask:0xf bank_mask:0xc
    v_mov_b32_dpp v58, v62 row_ror:8 row_mask:0xf bank_mask:0xc
    v_mov_b32_dpp v59, v63 row_ror:8 row_mask:0xf bank_mask:0xc
    v_mov_b32_dpp v60, v64 row_ror:8 row_mask:0xf bank_mask:0x3
    v_mov_b32_dpp v61, v65 row_ror:8 row_mask:0xf bank_mask:0x3
    v_mov_b32_dpp v62, v66 row_ror:8 row_mask:0xf bank_mask:0x3
    v_mov_b32_dpp v63, v67 row_ror:8 row_mask:0xf bank_mask:0x3
    buffer_store_dwordx4 v[56:59], v14, s[16:19], s72 offen offset:0
    buffer_store_dwordx4 v[60:63], v14, s[16:19], s73 offen offset:0
    v_lshlrev_b32 v48, 16, v82
    v_and_b32 v49, 0xffff0000, v82
    v_lshlrev_b32 v50, 16, v83
    v_and_b32 v51, 0xffff0000, v83
    v_lshlrev_b32 v52, 16, v86
    v_and_b32 v53, 0xffff0000, v86
    v_lshlrev_b32 v54, 16, v87
    v_and_b32 v55, 0xffff0000, v87
    v_pk_mul_f32 v[132:133], v[132:133], v[16:17] op_sel:[0,1] op_sel_hi:[1,1]
    v_pk_mul_f32 v[134:135], v[134:135], v[16:17] op_sel:[0,1] op_sel_hi:[1,1]
    v_pk_mul_f32 v[140:141], v[140:141], v[16:17] op_sel:[0,1] op_sel_hi:[1,1]
    v_pk_mul_f32 v[142:143], v[142:143], v[16:17] op_sel:[0,1] op_sel_hi:[1,1]
    v_pk_fma_f32 v[132:133], v[48:49], v[18:19], v[132:133] op_sel:[0,1,0] op_sel_hi:[1,1,1]
    v_pk_fma_f32 v[134:135], v[50:51], v[18:19], v[134:135] op_sel:[0,1,0] op_sel_hi:[1,1,1]
    v_pk_fma_f32 v[140:141], v[52:53], v[18:19], v[140:141] op_sel:[0,1,0] op_sel_hi:[1,1,1]
    v_pk_fma_f32 v[142:143], v[54:55], v[18:19], v[142:143] op_sel:[0,1,0] op_sel_hi:[1,1,1]
    v_cvt_pk_bf16_f32 v68, v132, v133
    v_cvt_pk_bf16_f32 v69, v134, v135
    v_cvt_pk_bf16_f32 v70, v140, v141
    v_cvt_pk_bf16_f32 v71, v142, v143
    v_lshlrev_b32 v112, 16, v90
    v_and_b32 v113, 0xffff0000, v90
    v_lshlrev_b32 v114, 16, v91
    v_and_b32 v115, 0xffff0000, v91
    v_lshlrev_b32 v116, 16, v94
    v_and_b32 v117, 0xffff0000, v94
    v_lshlrev_b32 v118, 16, v95
    v_and_b32 v119, 0xffff0000, v95
    v_pk_mul_f32 v[148:149], v[148:149], v[16:17] op_sel:[0,1] op_sel_hi:[1,1]
    v_pk_mul_f32 v[150:151], v[150:151], v[16:17] op_sel:[0,1] op_sel_hi:[1,1]
    v_pk_mul_f32 v[156:157], v[156:157], v[16:17] op_sel:[0,1] op_sel_hi:[1,1]
    v_pk_mul_f32 v[158:159], v[158:159], v[16:17] op_sel:[0,1] op_sel_hi:[1,1]
    v_pk_fma_f32 v[148:149], v[112:113], v[18:19], v[148:149] op_sel:[0,1,0] op_sel_hi:[1,1,1]
    v_pk_fma_f32 v[150:151], v[114:115], v[18:19], v[150:151] op_sel:[0,1,0] op_sel_hi:[1,1,1]
    v_pk_fma_f32 v[156:157], v[116:117], v[18:19], v[156:157] op_sel:[0,1,0] op_sel_hi:[1,1,1]
    v_pk_fma_f32 v[158:159], v[118:119], v[18:19], v[158:159] op_sel:[0,1,0] op_sel_hi:[1,1,1]
    v_cvt_pk_bf16_f32 v72, v148, v149
    v_cvt_pk_bf16_f32 v73, v150, v151
    v_cvt_pk_bf16_f32 v74, v156, v157
    v_cvt_pk_bf16_f32 v75, v158, v159
    v_permlane16_swap_b32 v68, v70
    v_permlane16_swap_b32 v69, v71
    s_nop 0
    v_permlane16_swap_b32 v72, v74
    v_permlane16_swap_b32 v73, v75
    v_mov_b32 v76, v68
    v_mov_b32 v77, v69
    v_mov_b32 v78, v70
    v_mov_b32 v79, v71
    v_mov_b32_dpp v68, v72 row_ror:8 row_mask:0xf bank_mask:0xc
    v_mov_b32_dpp v69, v73 row_ror:8 row_mask:0xf bank_mask:0xc
    v_mov_b32_dpp v70, v74 row_ror:8 row_mask:0xf bank_mask:0xc
    v_mov_b32_dpp v71, v75 row_ror:8 row_mask:0xf bank_mask:0xc
    v_mov_b32_dpp v72, v76 row_ror:8 row_mask:0xf bank_mask:0x3
    v_mov_b32_dpp v73, v77 row_ror:8 row_mask:0xf bank_mask:0x3
    v_mov_b32_dpp v74, v78 row_ror:8 row_mask:0xf bank_mask:0x3
    v_mov_b32_dpp v75, v79 row_ror:8 row_mask:0xf bank_mask:0x3
    buffer_store_dwordx4 v[68:71], v14, s[16:19], s74 offen offset:0
    buffer_store_dwordx4 v[72:75], v14, s[16:19], s75 offen offset:0
    v_lshlrev_b32 v48, 16, v96
    v_and_b32 v49, 0xffff0000, v96
    v_lshlrev_b32 v50, 16, v97
    v_and_b32 v51, 0xffff0000, v97
    v_lshlrev_b32 v52, 16, v100
    v_and_b32 v53, 0xffff0000, v100
    v_lshlrev_b32 v54, 16, v101
    v_and_b32 v55, 0xffff0000, v101
    v_pk_mul_f32 v[160:161], v[160:161], v[16:17] op_sel:[0,0] op_sel_hi:[1,0]
    v_pk_mul_f32 v[162:163], v[162:163], v[16:17] op_sel:[0,0] op_sel_hi:[1,0]
    v_pk_mul_f32 v[168:169], v[168:169], v[16:17] op_sel:[0,0] op_sel_hi:[1,0]
    v_pk_mul_f32 v[170:171], v[170:171], v[16:17] op_sel:[0,0] op_sel_hi:[1,0]
    v_pk_fma_f32 v[160:161], v[48:49], v[18:19], v[160:161] op_sel:[0,0,0] op_sel_hi:[1,0,1]
    v_pk_fma_f32 v[162:163], v[50:51], v[18:19], v[162:163] op_sel:[0,0,0] op_sel_hi:[1,0,1]
    v_pk_fma_f32 v[168:169], v[52:53], v[18:19], v[168:169] op_sel:[0,0,0] op_sel_hi:[1,0,1]
    v_pk_fma_f32 v[170:171], v[54:55], v[18:19], v[170:171] op_sel:[0,0,0] op_sel_hi:[1,0,1]
    v_cvt_pk_bf16_f32 v56, v160, v161
    v_cvt_pk_bf16_f32 v57, v162, v163
    v_cvt_pk_bf16_f32 v58, v168, v169
    v_cvt_pk_bf16_f32 v59, v170, v171
    v_lshlrev_b32 v112, 16, v104
    v_and_b32 v113, 0xffff0000, v104
    v_lshlrev_b32 v114, 16, v105
    v_and_b32 v115, 0xffff0000, v105
    v_lshlrev_b32 v116, 16, v108
    v_and_b32 v117, 0xffff0000, v108
    v_lshlrev_b32 v118, 16, v109
    v_and_b32 v119, 0xffff0000, v109
    v_pk_mul_f32 v[176:177], v[176:177], v[16:17] op_sel:[0,0] op_sel_hi:[1,0]
    v_pk_mul_f32 v[178:179], v[178:179], v[16:17] op_sel:[0,0] op_sel_hi:[1,0]
    v_pk_mul_f32 v[184:185], v[184:185], v[16:17] op_sel:[0,0] op_sel_hi:[1,0]
    v_pk_mul_f32 v[186:187], v[186:187], v[16:17] op_sel:[0,0] op_sel_hi:[1,0]
    v_pk_fma_f32 v[176:177], v[112:113], v[18:19], v[176:177] op_sel:[0,0,0] op_sel_hi:[1,0,1]
    v_pk_fma_f32 v[178:179], v[114:115], v[18:19], v[178:179] op_sel:[0,0,0] op_sel_hi:[1,0,1]
    v_pk_fma_f32 v[184:185], v[116:117], v[18:19], v[184:185] op_sel:[0,0,0] op_sel_hi:[1,0,1]
    v_pk_fma_f32 v[186:187], v[118:119], v[18:19], v[186:187] op_sel:[0,0,0] op_sel_hi:[1,0,1]
    v_cvt_pk_bf16_f32 v60, v176, v177
    v_cvt_pk_bf16_f32 v61, v178, v179
    v_cvt_pk_bf16_f32 v62, v184, v185
    v_cvt_pk_bf16_f32 v63, v186, v187
    v_permlane16_swap_b32 v56, v58
    v_permlane16_swap_b32 v57, v59
    s_nop 0
    v_permlane16_swap_b32 v60, v62
    v_permlane16_swap_b32 v61, v63
    v_mov_b32 v64, v56
    v_mov_b32 v65, v57
    v_mov_b32 v66, v58
    v_mov_b32 v67, v59
    v_mov_b32_dpp v56, v60 row_ror:8 row_mask:0xf bank_mask:0xc
    v_mov_b32_dpp v57, v61 row_ror:8 row_mask:0xf bank_mask:0xc
    v_mov_b32_dpp v58, v62 row_ror:8 row_mask:0xf bank_mask:0xc
    v_mov_b32_dpp v59, v63 row_ror:8 row_mask:0xf bank_mask:0xc
    v_mov_b32_dpp v60, v64 row_ror:8 row_mask:0xf bank_mask:0x3
    v_mov_b32_dpp v61, v65 row_ror:8 row_mask:0xf bank_mask:0x3
    v_mov_b32_dpp v62, v66 row_ror:8 row_mask:0xf bank_mask:0x3
    v_mov_b32_dpp v63, v67 row_ror:8 row_mask:0xf bank_mask:0x3
    buffer_store_dwordx4 v[56:59], v14, s[16:19], s72 offen offset:128
    buffer_store_dwordx4 v[60:63], v14, s[16:19], s73 offen offset:128
    v_lshlrev_b32 v48, 16, v98
    v_and_b32 v49, 0xffff0000, v98
    v_lshlrev_b32 v50, 16, v99
    v_and_b32 v51, 0xffff0000, v99
    v_lshlrev_b32 v52, 16, v102
    v_and_b32 v53, 0xffff0000, v102
    v_lshlrev_b32 v54, 16, v103
    v_and_b32 v55, 0xffff0000, v103
    v_pk_mul_f32 v[164:165], v[164:165], v[16:17] op_sel:[0,1] op_sel_hi:[1,1]
    v_pk_mul_f32 v[166:167], v[166:167], v[16:17] op_sel:[0,1] op_sel_hi:[1,1]
    v_pk_mul_f32 v[172:173], v[172:173], v[16:17] op_sel:[0,1] op_sel_hi:[1,1]
    v_pk_mul_f32 v[174:175], v[174:175], v[16:17] op_sel:[0,1] op_sel_hi:[1,1]
    v_pk_fma_f32 v[164:165], v[48:49], v[18:19], v[164:165] op_sel:[0,1,0] op_sel_hi:[1,1,1]
    v_pk_fma_f32 v[166:167], v[50:51], v[18:19], v[166:167] op_sel:[0,1,0] op_sel_hi:[1,1,1]
    v_pk_fma_f32 v[172:173], v[52:53], v[18:19], v[172:173] op_sel:[0,1,0] op_sel_hi:[1,1,1]
    v_pk_fma_f32 v[174:175], v[54:55], v[18:19], v[174:175] op_sel:[0,1,0] op_sel_hi:[1,1,1]
    v_cvt_pk_bf16_f32 v68, v164, v165
    v_cvt_pk_bf16_f32 v69, v166, v167
    v_cvt_pk_bf16_f32 v70, v172, v173
    v_cvt_pk_bf16_f32 v71, v174, v175
    v_lshlrev_b32 v112, 16, v106
    v_and_b32 v113, 0xffff0000, v106
    v_lshlrev_b32 v114, 16, v107
    v_and_b32 v115, 0xffff0000, v107
    v_lshlrev_b32 v116, 16, v110
    v_and_b32 v117, 0xffff0000, v110
    v_lshlrev_b32 v118, 16, v111
    v_and_b32 v119, 0xffff0000, v111
    v_pk_mul_f32 v[180:181], v[180:181], v[16:17] op_sel:[0,1] op_sel_hi:[1,1]
    v_pk_mul_f32 v[182:183], v[182:183], v[16:17] op_sel:[0,1] op_sel_hi:[1,1]
    v_pk_mul_f32 v[188:189], v[188:189], v[16:17] op_sel:[0,1] op_sel_hi:[1,1]
    v_pk_mul_f32 v[190:191], v[190:191], v[16:17] op_sel:[0,1] op_sel_hi:[1,1]
    v_pk_fma_f32 v[180:181], v[112:113], v[18:19], v[180:181] op_sel:[0,1,0] op_sel_hi:[1,1,1]
    v_pk_fma_f32 v[182:183], v[114:115], v[18:19], v[182:183] op_sel:[0,1,0] op_sel_hi:[1,1,1]
    v_pk_fma_f32 v[188:189], v[116:117], v[18:19], v[188:189] op_sel:[0,1,0] op_sel_hi:[1,1,1]
    v_pk_fma_f32 v[190:191], v[118:119], v[18:19], v[190:191] op_sel:[0,1,0] op_sel_hi:[1,1,1]
    v_cvt_pk_bf16_f32 v72, v180, v181
    v_cvt_pk_bf16_f32 v73, v182, v183
    v_cvt_pk_bf16_f32 v74, v188, v189
    v_cvt_pk_bf16_f32 v75, v190, v191
    v_permlane16_swap_b32 v68, v70
    v_permlane16_swap_b32 v69, v71
    s_nop 0
    v_permlane16_swap_b32 v72, v74
    v_permlane16_swap_b32 v73, v75
    v_mov_b32 v76, v68
    v_mov_b32 v77, v69
    v_mov_b32 v78, v70
    v_mov_b32 v79, v71
    v_mov_b32_dpp v68, v72 row_ror:8 row_mask:0xf bank_mask:0xc
    v_mov_b32_dpp v69, v73 row_ror:8 row_mask:0xf bank_mask:0xc
    v_mov_b32_dpp v70, v74 row_ror:8 row_mask:0xf bank_mask:0xc
    v_mov_b32_dpp v71, v75 row_ror:8 row_mask:0xf bank_mask:0xc
    v_mov_b32_dpp v72, v76 row_ror:8 row_mask:0xf bank_mask:0x3
    v_mov_b32_dpp v73, v77 row_ror:8 row_mask:0xf bank_mask:0x3
    v_mov_b32_dpp v74, v78 row_ror:8 row_mask:0xf bank_mask:0x3
    v_mov_b32_dpp v75, v79 row_ror:8 row_mask:0xf bank_mask:0x3
    buffer_store_dwordx4 v[68:71], v14, s[16:19], s74 offen offset:128
    buffer_store_dwordx4 v[72:75], v14, s[16:19], s75 offen offset:128
    s_branch L_end
L_far:
    s_waitcnt lgkmcnt(8)
    v_mfma_f32_16x16x32_bf16 v[128:131], a[128:131], v[192:195], v[128:131]
    ds_read_b64_tr_b16 a[152:153], v33 offset:256
    ds_read_b64_tr_b16 a[154:155], v33 offset:8448
    v_mfma_f32_16x16x32_bf16 v[132:135], a[128:131], v[196:199], v[132:135]
    v_and_b32 v14, 7, v0
    v_lshlrev_b32 v14, 9, v14
    v_mfma_f32_16x16x32_bf16 v[128:131], a[132:135], v[200:203], v[128:131]
    ds_read_b64_tr_b16 a[156:157], v33 offset:16640
    ds_read_b64_tr_b16 a[158:159], v33 offset:24832
    v_mfma_f32_16x16x32_bf16 v[132:135], a[132:135], v[204:207], v[132:135]
    s_waitcnt lgkmcnt(8)
    v_bfe_u32 v15, v0, 4, 1
    v_lshl_add_u32 v14, v15, 5, v14
    v_mfma_f32_16x16x32_bf16 v[136:139], a[136:139], v[192:195], v[136:139]
    v_mfma_f32_16x16x32_bf16 v[140:143], a[136:139], v[196:199], v[140:143]
    v_lshrrev_b32 v15, 5, v0
    v_lshl_add_u32 v14, v15, 4, v14
    v_mfma_f32_16x16x32_bf16 v[136:139], a[140:143], v[200:203], v[136:139]
    v_mfma_f32_16x16x32_bf16 v[140:143], a[140:143], v[204:207], v[140:143]
    s_waitcnt lgkmcnt(4)
    v_bfe_u32 v15, v0, 3, 1
    v_lshl_add_u32 v14, v15, 6, v14
    v_cvt_pk_bf16_f32 v48, v128, v129
    v_cvt_pk_bf16_f32 v49, v130, v131
    v_mfma_f32_16x16x32_bf16 v[144:147], a[144:147], v[192:195], v[144:147]
    ds_read_b64_tr_b16 a[160:161], v34 offset:256
    ds_read_b64_tr_b16 a[162:163], v34 offset:8448
    v_cvt_pk_bf16_f32 v50, v132, v133
    v_mfma_f32_16x16x32_bf16 v[148:151], a[144:147], v[196:199], v[148:151]
    v_mov_b32 v18, v240
    s_mov_b32 s55, 1000000
    v_cvt_pk_bf16_f32 v51, v134, v135
    buffer_store_dwordx4 v[48:51], v1, s[16:19], s68 offen offset:0 sc1
    v_mfma_f32_16x16x32_bf16 v[144:147], a[148:151], v[200:203], v[144:147]
    ds_read_b64_tr_b16 a[164:165], v34 offset:16640
    ds_read_b64_tr_b16 a[166:167], v34 offset:24832
    v_mfma_f32_16x16x32_bf16 v[148:151], a[148:151], v[204:207], v[148:151]
    s_waitcnt lgkmcnt(4)
    v_cvt_pk_bf16_f32 v52, v136, v137
    v_cvt_pk_bf16_f32 v53, v138, v139
    v_mfma_f32_16x16x32_bf16 v[152:155], a[152:155], v[192:195], v[152:155]
    ds_read_b64_tr_b16 a[168:169], v35 offset:256
    ds_read_b64_tr_b16 a[170:171], v35 offset:8448
    v_cvt_pk_bf16_f32 v54, v140, v141
    v_mfma_f32_16x16x32_bf16 v[156:159], a[152:155], v[196:199], v[156:159]
    v_cvt_pk_bf16_f32 v55, v142, v143
    buffer_store_dwordx4 v[52:55], v1, s[16:19], s68 offen offset:2048 sc1
    v_mfma_f32_16x16x32_bf16 v[152:155], a[156:159], v[200:203], v[152:155]
    ds_read_b64_tr_b16 a[172:173], v35 offset:16640
    ds_read_b64_tr_b16 a[174:175], v35 offset:24832
    v_add3_u32 v18, v52, v53, v18
    v_add3_u32 v18, v54, v55, v18
    v_mfma_f32_16x16x32_bf16 v[156:159], a[156:159], v[204:207], v[156:159]
    v_cvt_pk_bf16_f32 v56, v144, v145
    v_cvt_pk_bf16_f32 v57, v146, v147
    v_mfma_f32_16x16x32_bf16 a[196:199], a[192:195], v[192:195], a[196:199]
    ds_read_b64_tr_b16 a[176:177], v36 offset:256
    ds_read_b64_tr_b16 a[178:179], v36 offset:8448
    v_cvt_pk_bf16_f32 v58, v148, v149
    v_mfma_f32_16x16x32_bf16 a[200:203], a[192:195], v[196:199], a[200:203]
    v_cvt_pk_bf16_f32 v59, v150, v151
    buffer_store_dwordx4 v[56:59], v1, s[16:19], s69 offen offset:0 sc1
    v_mfma_f32_16x16x32_bf16 a[196:199], a[192:195], v[200:203], a[196:199]
    ds_read_b64_tr_b16 a[180:181], v36 offset:16640
    ds_read_b64_tr_b16 a[182:183], v36 offset:24832
    v_add3_u32 v18, v56, v57, v18
    v_add3_u32 v18, v58, v59, v18
    v_mfma_f32_16x16x32_bf16 a[200:203], a[192:195], v[204:207], a[200:203]
    s_waitcnt lgkmcnt(8)
    v_cvt_pk_bf16_f32 v60, v152, v153
    v_cvt_pk_bf16_f32 v61, v154, v155
    v_mfma_f32_16x16x32_bf16 v[160:163], a[160:163], v[192:195], v[160:163]
    ds_read_b64_tr_b16 a[184:185], v37 offset:256
    ds_read_b64_tr_b16 a[186:187], v37 offset:8448
    v_cvt_pk_bf16_f32 v62, v156, v157
    v_mfma_f32_16x16x32_bf16 v[164:167], a[160:163], v[196:199], v[164:167]
    v_cvt_pk_bf16_f32 v63, v158, v159
    buffer_store_dwordx4 v[60:63], v1, s[16:19], s69 offen offset:2048 sc1
    v_mfma_f32_16x16x32_bf16 v[160:163], a[164:167], v[200:203], v[160:163]
    ds_read_b64_tr_b16 a[188:189], v37 offset:16640
    ds_read_b64_tr_b16 a[190:191], v37 offset:24832
    v_add3_u32 v18, v60, v61, v18
    v_add3_u32 v18, v62, v63, v18
    v_mfma_f32_16x16x32_bf16 v[164:167], a[164:167], v[204:207], v[164:167]
    s_waitcnt lgkmcnt(8)
    v_mfma_f32_16x16x32_bf16 v[168:171], a[168:171], v[192:195], v[168:171]
    ds_read_b64_tr_b16 a[128:129], v30 offset:0
    ds_read_b64_tr_b16 a[130:131], v30 offset:8192
    v_mfma_f32_16x16x32_bf16 v[172:175], a[168:171], v[196:199], v[172:175]
    v_accvgpr_read_b32 v40, a196
    v_accvgpr_read_b32 v41, a200
    v_mfma_f32_16x16x32_bf16 v[168:171], a[172:175], v[200:203], v[168:171]
    ds_read_b64_tr_b16 a[132:133], v30 offset:16384
    ds_read_b64_tr_b16 a[134:135], v30 offset:24576
    v_mfma_f32_16x16x32_bf16 v[172:175], a[172:175], v[204:207], v[172:175]
    s_waitcnt lgkmcnt(8)
    v_cndmask_b32 v16, v38, v39, s[66:67]
    v_cndmask_b32 v17, v40, v41, s[66:67]
    v_cvt_pk_bf16_f32 v64, v160, v161
    v_cvt_pk_bf16_f32 v65, v162, v163
    v_mfma_f32_16x16x32_bf16 v[176:179], a[176:179], v[192:195], v[176:179]
    ds_read_b64_tr_b16 a[136:137], v31 offset:0
    ds_read_b64_tr_b16 a[138:139], v31 offset:8192
    v_cvt_pk_bf16_f32 v66, v164, v165
    v_mfma_f32_16x16x32_bf16 v[180:183], a[176:179], v[196:199], v[180:183]
    v_add3_u32 v18, v16, v17, v18
    v_cvt_pk_bf16_f32 v67, v166, v167
    buffer_store_dwordx4 v[64:67], v1, s[16:19], s70 offen offset:0 sc1
    v_mfma_f32_16x16x32_bf16 v[176:179], a[180:183], v[200:203], v[176:179]
    ds_read_b64_tr_b16 a[140:141], v31 offset:16384
    ds_read_b64_tr_b16 a[142:143], v31 offset:24576
    v_add3_u32 v18, v64, v65, v18
    v_add3_u32 v18, v66, v67, v18
    v_add3_u32 v18, v48, v49, v18
    v_add3_u32 v18, v50, v51, v18
    v_mfma_f32_16x16x32_bf16 v[180:183], a[180:183], v[204:207], v[180:183]
    s_waitcnt lgkmcnt(8)
    v_cvt_pk_bf16_f32 v68, v168, v169
    v_cvt_pk_bf16_f32 v69, v170, v171
    v_mfma_f32_16x16x32_bf16 v[184:187], a[184:187], v[192:195], v[184:187]
    ds_read_b64_tr_b16 a[144:145], v32 offset:0
    ds_read_b64_tr_b16 a[146:147], v32 offset:8192
    v_cvt_pk_bf16_f32 v70, v172, v173
    v_mfma_f32_16x16x32_bf16 v[188:191], a[184:187], v[196:199], v[188:191]
    v_cvt_pk_bf16_f32 v71, v174, v175
    buffer_store_dwordx4 v[68:71], v1, s[16:19], s70 offen offset:2048 sc1
    v_mfma_f32_16x16x32_bf16 v[184:187], a[188:191], v[200:203], v[184:187]
    ds_read_b64_tr_b16 a[148:149], v32 offset:16384
    ds_read_b64_tr_b16 a[150:151], v32 offset:24576
    v_add3_u32 v18, v68, v69, v18
    v_add3_u32 v18, v70, v71, v18
    v_mfma_f32_16x16x32_bf16 v[188:191], a[188:191], v[204:207], v[188:191]
    s_waitcnt lgkmcnt(8)
    v_cvt_pk_bf16_f32 v72, v176, v177
    v_cvt_pk_bf16_f32 v73, v178, v179
    v_mfma_f32_16x16x32_bf16 a[0:3], a[128:131], v[192:195], a[0:3]
    ds_read_b64_tr_b16 a[152:153], v33 offset:0
    ds_read_b64_tr_b16 a[154:155], v33 offset:8192
    v_cvt_pk_bf16_f32 v74, v180, v181
    v_mfma_f32_16x16x32_bf16 a[4:7], a[128:131], v[196:199], a[4:7]
    v_cvt_pk_bf16_f32 v75, v182, v183
    buffer_store_dwordx4 v[72:75], v1, s[16:19], s71 offen offset:0 sc1
    v_mfma_f32_16x16x32_bf16 a[0:3], a[132:135], v[200:203], a[0:3]
    ds_read_b64_tr_b16 a[156:157], v33 offset:16384
    ds_read_b64_tr_b16 a[158:159], v33 offset:24576
    v_add3_u32 v18, v72, v73, v18
    v_add3_u32 v18, v74, v75, v18
    v_mfma_f32_16x16x32_bf16 a[4:7], a[132:135], v[204:207], a[4:7]
    s_waitcnt lgkmcnt(8)
    v_cvt_pk_bf16_f32 v76, v184, v185
    v_cvt_pk_bf16_f32 v77, v186, v187
    v_mfma_f32_16x16x32_bf16 a[8:11], a[136:139], v[192:195], a[8:11]
    ds_read_b64_tr_b16 a[160:161], v34 offset:0
    ds_read_b64_tr_b16 a[162:163], v34 offset:8192
    v_cvt_pk_bf16_f32 v78, v188, v189
    v_mfma_f32_16x16x32_bf16 a[12:15], a[136:139], v[196:199], a[12:15]
    v_cvt_pk_bf16_f32 v79, v190, v191
    buffer_store_dwordx4 v[76:79], v1, s[16:19], s71 offen offset:2048 sc1
    v_mfma_f32_16x16x32_bf16 a[8:11], a[140:143], v[200:203], a[8:11]
    ds_read_b64_tr_b16 a[164:165], v34 offset:16384
    ds_read_b64_tr_b16 a[166:167], v34 offset:24576
    v_add3_u32 v18, v76, v77, v18
    v_add3_u32 v18, v78, v79, v18
    v_mfma_f32_16x16x32_bf16 a[12:15], a[140:143], v[204:207], a[12:15]
    s_waitcnt lgkmcnt(8)
    buffer_store_dwordx4 v[16:19], v241, s[88:91], s92 offen sc1
    v_mfma_f32_16x16x32_bf16 a[16:19], a[144:147], v[192:195], a[16:19]
    ds_read_b64_tr_b16 a[168:169], v35 offset:0
    ds_read_b64_tr_b16 a[170:171], v35 offset:8192
    v_mfma_f32_16x16x32_bf16 a[20:23], a[144:147], v[196:199], a[20:23]
    v_accvgpr_read_b32 v128, a0
    v_accvgpr_read_b32 v129, a1
    v_mfma_f32_16x16x32_bf16 a[16:19], a[148:151], v[200:203], a[16:19]
    ds_read_b64_tr_b16 a[172:173], v35 offset:16384
    ds_read_b64_tr_b16 a[174:175], v35 offset:24576
    v_mfma_f32_16x16x32_bf16 a[20:23], a[148:151], v[204:207], a[20:23]
    s_waitcnt lgkmcnt(8)
    v_accvgpr_read_b32 v130, a2
    v_accvgpr_read_b32 v131, a3
    v_mfma_f32_16x16x32_bf16 a[24:27], a[152:155], v[192:195], a[24:27]
    ds_read_b64_tr_b16 a[176:177], v36 offset:0
    ds_read_b64_tr_b16 a[178:179], v36 offset:8192
    v_mfma_f32_16x16x32_bf16 a[28:31], a[152:155], v[196:199], a[28:31]
    v_accvgpr_read_b32 v132, a4
    v_accvgpr_read_b32 v133, a5
    v_accvgpr_read_b32 v136, a8
    v_accvgpr_read_b32 v137, a9
    v_mfma_f32_16x16x32_bf16 a[24:27], a[156:159], v[200:203], a[24:27]
    ds_read_b64_tr_b16 a[180:181], v36 offset:16384
    ds_read_b64_tr_b16 a[182:183], v36 offset:24576
    buffer_load_dwordx4 v[80:83], v1, s[16:19], s72 offen offset:0 sc1
    v_mfma_f32_16x16x32_bf16 a[28:31], a[156:159], v[204:207], a[28:31]
    s_waitcnt lgkmcnt(8)
    buffer_load_dwordx4 v[84:87], v1, s[16:19], s72 offen offset:2048 sc1
    v_accvgpr_read_b32 v134, a6
    v_accvgpr_read_b32 v135, a7
    v_accvgpr_read_b32 v138, a10
    v_accvgpr_read_b32 v139, a11
    v_mfma_f32_16x16x32_bf16 a[32:35], a[160:163], v[192:195], a[32:35]
    ds_read_b64_tr_b16 a[184:185], v37 offset:0
    ds_read_b64_tr_b16 a[186:187], v37 offset:8192
    buffer_load_dwordx4 v[88:91], v1, s[16:19], s73 offen offset:0 sc1
    v_mfma_f32_16x16x32_bf16 a[36:39], a[160:163], v[196:199], a[36:39]
    buffer_load_dwordx4 v[92:95], v1, s[16:19], s73 offen offset:2048 sc1
    v_accvgpr_read_b32 v140, a12
    v_accvgpr_read_b32 v141, a13
    v_accvgpr_read_b32 v144, a16
    v_accvgpr_read_b32 v145, a17
    v_mfma_f32_16x16x32_bf16 a[32:35], a[164:167], v[200:203], a[32:35]
    ds_read_b64_tr_b16 a[188:189], v37 offset:16384
    ds_read_b64_tr_b16 a[190:191], v37 offset:24576
    buffer_load_dwordx4 v[96:99], v1, s[16:19], s74 offen offset:0 sc1
    v_mfma_f32_16x16x32_bf16 a[36:39], a[164:167], v[204:207], a[36:39]
    s_waitcnt lgkmcnt(8)
    buffer_load_dwordx4 v[100:103], v1, s[16:19], s74 offen offset:2048 sc1
    v_accvgpr_read_b32 v142, a14
    v_accvgpr_read_b32 v143, a15
    v_accvgpr_read_b32 v146, a18
    v_accvgpr_read_b32 v147, a19
    v_mfma_f32_16x16x32_bf16 a[40:43], a[168:171], v[192:195], a[40:43]
    buffer_load_dwordx4 v[104:107], v1, s[16:19], s75 offen offset:0 sc1
    v_mfma_f32_16x16x32_bf16 a[44:47], a[168:171], v[196:199], a[44:47]
    buffer_load_dwordx4 v[108:111], v1, s[16:19], s75 offen offset:2048 sc1
    v_accvgpr_read_b32 v148, a20
    v_accvgpr_read_b32 v149, a21
    v_accvgpr_read_b32 v152, a24
    v_accvgpr_read_b32 v153, a25
    v_mfma_f32_16x16x32_bf16 a[40:43], a[172:175], v[200:203], a[40:43]
    buffer_load_dwordx4 v[44:47], v241, s[88:91], s93 offen sc1
    v_mfma_f32_16x16x32_bf16 a[44:47], a[172:175], v[204:207], a[44:47]
    s_waitcnt lgkmcnt(4)
    v_accvgpr_read_b32 v150, a22
    v_accvgpr_read_b32 v151, a23
    v_accvgpr_read_b32 v154, a26
    v_accvgpr_read_b32 v155, a27
    v_mfma_f32_16x16x32_bf16 a[48:51], a[176:179], v[192:195], a[48:51]
    v_mfma_f32_16x16x32_bf16 a[52:55], a[176:179], v[196:199], a[52:55]
    v_accvgpr_read_b32 v156, a28
    v_accvgpr_read_b32 v157, a29
    v_accvgpr_read_b32 v160, a32
    v_accvgpr_read_b32 v161, a33
    v_mfma_f32_16x16x32_bf16 a[48:51], a[180:183], v[200:203], a[48:51]
    v_mfma_f32_16x16x32_bf16 a[52:55], a[180:183], v[204:207], a[52:55]
    s_waitcnt lgkmcnt(0)
    v_accvgpr_read_b32 v158, a30
    v_accvgpr_read_b32 v159, a31
    v_accvgpr_read_b32 v162, a34
    v_accvgpr_read_b32 v163, a35
    v_mfma_f32_16x16x32_bf16 a[56:59], a[184:187], v[192:195], a[56:59]
    v_mfma_f32_16x16x32_bf16 a[60:63], a[184:187], v[196:199], a[60:63]
    v_accvgpr_read_b32 v164, a36
    v_accvgpr_read_b32 v165, a37
    v_mfma_f32_16x16x32_bf16 a[56:59], a[188:191], v[200:203], a[56:59]
    v_mfma_f32_16x16x32_bf16 a[60:63], a[188:191], v[204:207], a[60:63]
    v_accvgpr_read_b32 v166, a38
    v_accvgpr_read_b32 v167, a39
    s_nop 7
    v_accvgpr_read_b32 v168, a40
    v_accvgpr_read_b32 v169, a41
    v_accvgpr_read_b32 v170, a42
    v_accvgpr_read_b32 v171, a43
    v_accvgpr_read_b32 v172, a44
    v_accvgpr_read_b32 v173, a45
    v_accvgpr_read_b32 v174, a46
    v_accvgpr_read_b32 v175, a47
    v_accvgpr_read_b32 v176, a48
    v_accvgpr_read_b32 v177, a49
    v_accvgpr_read_b32 v178, a50
    v_accvgpr_read_b32 v179, a51
    v_accvgpr_read_b32 v180, a52
    v_accvgpr_read_b32 v181, a53
    v_accvgpr_read_b32 v182, a54
    v_accvgpr_read_b32 v183, a55
    v_accvgpr_read_b32 v184, a56
    v_accvgpr_read_b32 v185, a57
    v_accvgpr_read_b32 v186, a58
    v_accvgpr_read_b32 v187, a59
    v_accvgpr_read_b32 v188, a60
    v_accvgpr_read_b32 v189, a61
    v_accvgpr_read_b32 v190, a62
    v_accvgpr_read_b32 v191, a63
L_retry_f:
    s_waitcnt vmcnt(0)
    v_add3_u32 v42, v44, v45, s27
    v_add3_u32 v43, v80, v81, v82
    v_add_u32 v42, v42, v83
    v_add3_u32 v43, v84, v85, v43
    v_add3_u32 v42, v86, v87, v42
    v_add3_u32 v43, v88, v89, v43
    v_add3_u32 v42, v90, v91, v42
    v_add3_u32 v43, v92, v93, v43
    v_add3_u32 v42, v94, v95, v42
    v_add3_u32 v43, v96, v97, v43
    v_add3_u32 v42, v98, v99, v42
    v_add3_u32 v43, v100, v101, v43
    v_add3_u32 v42, v102, v103, v42
    v_add3_u32 v43, v104, v105, v43
    v_add3_u32 v42, v106, v107, v42
    v_add3_u32 v43, v108, v109, v43
    v_add3_u32 v42, v110, v111, v42
    v_add_u32 v42, v42, v43
    v_cmp_ne_u32 vcc, v46, v42
    s_cbranch_vccz L_got_f
    buffer_load_dword v15, off, s[88:91], s95 sc1
    buffer_load_dwordx4 v[80:83], v1, s[16:19], s72 offen offset:0 sc1
    buffer_load_dwordx4 v[84:87], v1, s[16:19], s72 offen offset:2048 sc1
    buffer_load_dwordx4 v[88:91], v1, s[16:19], s73 offen offset:0 sc1
    buffer_load_dwordx4 v[92:95], v1, s[16:19], s73 offen offset:2048 sc1
    buffer_load_dwordx4 v[96:99], v1, s[16:19], s74 offen offset:0 sc1
    buffer_load_dwordx4 v[100:103], v1, s[16:19], s74 offen offset:2048 sc1
    buffer_load_dwordx4 v[104:107], v1, s[16:19], s75 offen offset:0 sc1
    buffer_load_dwordx4 v[108:111], v1, s[16:19], s75 offen offset:2048 sc1
    buffer_load_dwordx4 v[44:47], v241, s[88:91], s93 offen sc1
    s_waitcnt vmcnt(9)
    v_cmp_ne_u32 vcc, v15, v240
    s_cbranch_vccz L_same_f
    v_sub_u32 v18, v18, v240
    v_add_u32 v18, v18, v15
    v_mov_b32 v240, v15
    buffer_store_dwordx4 v[48:51], v1, s[16:19], s68 offen offset:0 sc1
    buffer_store_dwordx4 v[52:55], v1, s[16:19], s68 offen offset:2048 sc1
    buffer_store_dwordx4 v[56:59], v1, s[16:19], s69 offen offset:0 sc1
    buffer_store_dwordx4 v[60:63], v1, s[16:19], s69 offen offset:2048 sc1
    buffer_store_dwordx4 v[64:67], v1, s[16:19], s70 offen offset:0 sc1
    buffer_store_dwordx4 v[68:71], v1, s[16:19], s70 offen offset:2048 sc1
    buffer_store_dwordx4 v[72:75], v1, s[16:19], s71 offen offset:0 sc1
    buffer_store_dwordx4 v[76:79], v1, s[16:19], s71 offen offset:2048 sc1
    buffer_store_dwordx4 v[16:19], v241, s[88:91], s92 offen sc1
L_same_f:
    s_sub_u32 s55, s55, 1
    s_cmp_lg_u32 s55, 0
    s_cbranch_scc1 L_retry_f
    s_waitcnt vmcnt(0)
L_got_f:
    v_mov_b32 v46, v44
    v_mov_b32 v47, v45
    s_nop 1
    v_permlane16_swap_b32 v44, v46
    v_permlane16_swap_b32 v45, v47
    s_nop 0
    v_max_f32 v42, v38, v44
    v_max_f32 v43, v39, v46
    v_sub_f32 v16, v38, v42
    v_sub_f32 v17, v39, v43
    v_sub_f32 v18, v44, v42
    v_sub_f32 v19, v46, v43
    v_exp_f32 v16, v16
    v_exp_f32 v17, v17
    v_exp_f32 v18, v18
    v_exp_f32 v19, v19
    v_mul_f32 v42, v16, v40
    v_mul_f32 v43, v17, v41
    v_fmac_f32 v42, v18, v45
    v_fmac_f32 v43, v19, v47
    v_rcp_f32 v42, v42
    v_rcp_f32 v43, v43
    s_nop 0
    v_mul_f32 v16, v16, v42
    v_mul_f32 v17, v17, v43
    v_mul_f32 v18, v18, v42
    v_mul_f32 v19, v19, v43
    v_lshlrev_b32 v48, 16, v80
    v_and_b32 v49, 0xffff0000, v80
    v_lshlrev_b32 v50, 16, v81
    v_and_b32 v51, 0xffff0000, v81
    v_lshlrev_b32 v52, 16, v84
    v_and_b32 v53, 0xffff0000, v84
    v_lshlrev_b32 v54, 16, v85
    v_and_b32 v55, 0xffff0000, v85
    v_pk_mul_f32 v[128:129], v[128:129], v[16:17] op_sel:[0,0] op_sel_hi:[1,0]
    v_pk_mul_f32 v[130:131], v[130:131], v[16:17] op_sel:[0,0] op_sel_hi:[1,0]
    v_pk_mul_f32 v[136:137], v[136:137], v[16:17] op_sel:[0,0] op_sel_hi:[1,0]
    v_pk_mul_f32 v[138:139], v[138:139], v[16:17] op_sel:[0,0] op_sel_hi:[1,0]
    v_pk_fma_f32 v[128:129], v[48:49], v[18:19], v[128:129] op_sel:[0,0,0] op_sel_hi:[1,0,1]
    v_pk_fma_f32 v[130:131], v[50:51], v[18:19], v[130:131] op_sel:[0,0,0] op_sel_hi:[1,0,1]
    v_pk_fma_f32 v[136:137], v[52:53], v[18:19], v[136:137] op_sel:[0,0,0] op_sel_hi:[1,0,1]
    v_pk_fma_f32 v[138:139], v[54:55], v[18:19], v[138:139] op_sel:[0,0,0] op_sel_hi:[1,0,1]
    v_cvt_pk_bf16_f32 v56, v128, v129
    v_cvt_pk_bf16_f32 v57, v130, v131
    v_cvt_pk_bf16_f32 v58, v136, v137
    v_cvt_pk_bf16_f32 v59, v138, v139
    v_lshlrev_b32 v112, 16, v88
    v_and_b32 v113, 0xffff0000, v88
    v_lshlrev_b32 v114, 16, v89
    v_and_b32 v115, 0xffff0000, v89
    v_lshlrev_b32 v116, 16, v92
    v_and_b32 v117, 0xffff0000, v92
    v_lshlrev_b32 v118, 16, v93
    v_and_b32 v119, 0xffff0000, v93
    v_pk_mul_f32 v[144:145], v[144:145], v[16:17] op_sel:[0,0] op_sel_hi:[1,0]
    v_pk_mul_f32 v[146:147], v[146:147], v[16:17] op_sel:[0,0] op_sel_hi:[1,0]
    v_pk_mul_f32 v[152:153], v[152:153], v[16:17] op_sel:[0,0] op_sel_hi:[1,0]
    v_pk_mul_f32 v[154:155], v[154:155], v[16:17] op_sel:[0,0] op_sel_hi:[1,0]
    v_pk_fma_f32 v[144:145], v[112:113], v[18:19], v[144:145] op_sel:[0,0,0] op_sel_hi:[1,0,1]
    v_pk_fma_f32 v[146:147], v[114:115], v[18:19], v[146:147] op_sel:[0,0,0] op_sel_hi:[1,0,1]
    v_pk_fma_f32 v[152:153], v[116:117], v[18:19], v[152:153] op_sel:[0,0,0] op_sel_hi:[1,0,1]
    v_pk_fma_f32 v[154:155], v[118:119], v[18:19], v[154:155] op_sel:[0,0,0] op_sel_hi:[1,0,1]
    v_cvt_pk_bf16_f32 v60, v144, v145
    v_cvt_pk_bf16_f32 v61, v146, v147
    v_cvt_pk_bf16_f32 v62, v152, v153
    v_cvt_pk_bf16_f32 v63, v154, v155
    v_permlane16_swap_b32 v56, v58
    v_permlane16_swap_b32 v57, v59
    s_nop 0
    v_permlane16_swap_b32 v60, v62
    v_permlane16_swap_b32 v61, v63
    v_mov_b32 v64, v56
    v_mov_b32 v65, v57
    v_mov_b32 v66, v58
    v_mov_b32 v67, v59
    v_mov_b32_dpp v56, v60 row_ror:8 row_mask:0xf bank_mask:0xc
    v_mov_b32_dpp v57, v61 row_ror:8 row_mask:0xf bank_mask:0xc
    v_mov_b32_dpp v58, v62 row_ror:8 row_mask:0xf bank_mask:0xc
    v_mov_b32_dpp v59, v63 row_ror:8 row_mask:0xf bank_mask:0xc
    v_mov_b32_dpp v60, v64 row_ror:8 row_mask:0xf bank_mask:0x3
    v_mov_b32_dpp v61, v65 row_ror:8 row_mask:0xf bank_mask:0x3
    v_mov_b32_dpp v62, v66 row_ror:8 row_mask:0xf bank_mask:0x3
    v_mov_b32_dpp v63, v67 row_ror:8 row_mask:0xf bank_mask:0x3
    buffer_store_dwordx4 v[56:59], v14, s[16:19], s72 offen offset:0
    buffer_store_dwordx4 v[60:63], v14, s[16:19], s73 offen offset:0
    v_lshlrev_b32 v48, 16, v82
    v_and_b32 v49, 0xffff0000, v82
    v_lshlrev_b32 v50, 16, v83
    v_and_b32 v51, 0xffff0000, v83
    v_lshlrev_b32 v52, 16, v86
    v_and_b32 v53, 0xffff0000, v86
    v_lshlrev_b32 v54, 16, v87
    v_and_b32 v55, 0xffff0000, v87
    v_pk_mul_f32 v[132:133], v[132:133], v[16:17] op_sel:[0,1] op_sel_hi:[1,1]
    v_pk_mul_f32 v[134:135], v[134:135], v[16:17] op_sel:[0,1] op_sel_hi:[1,1]
    v_pk_mul_f32 v[140:141], v[140:141], v[16:17] op_sel:[0,1] op_sel_hi:[1,1]
    v_pk_mul_f32 v[142:143], v[142:143], v[16:17] op_sel:[0,1] op_sel_hi:[1,1]
    v_pk_fma_f32 v[132:133], v[48:49], v[18:19], v[132:133] op_sel:[0,1,0] op_sel_hi:[1,1,1]
    v_pk_fma_f32 v[134:135], v[50:51], v[18:19], v[134:135] op_sel:[0,1,0] op_sel_hi:[1,1,1]
    v_pk_fma_f32 v[140:141], v[52:53], v[18:19], v[140:141] op_sel:[0,1,0] op_sel_hi:[1,1,1]
    v_pk_fma_f32 v[142:143], v[54:55], v[18:19], v[142:143] op_sel:[0,1,0] op_sel_hi:[1,1,1]
    v_cvt_pk_bf16_f32 v68, v132, v133
    v_cvt_pk_bf16_f32 v69, v134, v135
    v_cvt_pk_bf16_f32 v70, v140, v141
    v_cvt_pk_bf16_f32 v71, v142, v143
    v_lshlrev_b32 v112, 16, v90
    v_and_b32 v113, 0xffff0000, v90
    v_lshlrev_b32 v114, 16, v91
    v_and_b32 v115, 0xffff0000, v91
    v_lshlrev_b32 v116, 16, v94
    v_and_b32 v117, 0xffff0000, v94
    v_lshlrev_b32 v118, 16, v95
    v_and_b32 v119, 0xffff0000, v95
    v_pk_mul_f32 v[148:149], v[148:149], v[16:17] op_sel:[0,1] op_sel_hi:[1,1]
    v_pk_mul_f32 v[150:151], v[150:151], v[16:17] op_sel:[0,1] op_sel_hi:[1,1]
    v_pk_mul_f32 v[156:157], v[156:157], v[16:17] op_sel:[0,1] op_sel_hi:[1,1]
    v_pk_mul_f32 v[158:159], v[158:159], v[16:17] op_sel:[0,1] op_sel_hi:[1,1]
    v_pk_fma_f32 v[148:149], v[112:113], v[18:19], v[148:149] op_sel:[0,1,0] op_sel_hi:[1,1,1]
    v_pk_fma_f32 v[150:151], v[114:115], v[18:19], v[150:151] op_sel:[0,1,0] op_sel_hi:[1,1,1]
    v_pk_fma_f32 v[156:157], v[116:117], v[18:19], v[156:157] op_sel:[0,1,0] op_sel_hi:[1,1,1]
    v_pk_fma_f32 v[158:159], v[118:119], v[18:19], v[158:159] op_sel:[0,1,0] op_sel_hi:[1,1,1]
    v_cvt_pk_bf16_f32 v72, v148, v149
    v_cvt_pk_bf16_f32 v73, v150, v151
    v_cvt_pk_bf16_f32 v74, v156, v157
    v_cvt_pk_bf16_f32 v75, v158, v159
    v_permlane16_swap_b32 v68, v70
    v_permlane16_swap_b32 v69, v71
    s_nop 0
    v_permlane16_swap_b32 v72, v74
    v_permlane16_swap_b32 v73, v75
    v_mov_b32 v76, v68
    v_mov_b32 v77, v69
    v_mov_b32 v78, v70
    v_mov_b32 v79, v71
    v_mov_b32_dpp v68, v72 row_ror:8 row_mask:0xf bank_mask:0xc
    v_mov_b32_dpp v69, v73 row_ror:8 row_mask:0xf bank_mask:0xc
    v_mov_b32_dpp v70, v74 row_ror:8 row_mask:0xf bank_mask:0xc
    v_mov_b32_dpp v71, v75 row_ror:8 row_mask:0xf bank_mask:0xc
    v_mov_b32_dpp v72, v76 row_ror:8 row_mask:0xf bank_mask:0x3
    v_mov_b32_dpp v73, v77 row_ror:8 row_mask:0xf bank_mask:0x3
    v_mov_b32_dpp v74, v78 row_ror:8 row_mask:0xf bank_mask:0x3
    v_mov_b32_dpp v75, v79 row_ror:8 row_mask:0xf bank_mask:0x3
    buffer_store_dwordx4 v[68:71], v14, s[16:19], s74 offen offset:0
    buffer_store_dwordx4 v[72:75], v14, s[16:19], s75 offen offset:0
    v_lshlrev_b32 v48, 16, v96
    v_and_b32 v49, 0xffff0000, v96
    v_lshlrev_b32 v50, 16, v97
    v_and_b32 v51, 0xffff0000, v97
    v_lshlrev_b32 v52, 16, v100
    v_and_b32 v53, 0xffff0000, v100
    v_lshlrev_b32 v54, 16, v101
    v_and_b32 v55, 0xffff0000, v101
    v_pk_mul_f32 v[160:161], v[160:161], v[16:17] op_sel:[0,0] op_sel_hi:[1,0]
    v_pk_mul_f32 v[162:163], v[162:163], v[16:17] op_sel:[0,0] op_sel_hi:[1,0]
    v_pk_mul_f32 v[168:169], v[168:169], v[16:17] op_sel:[0,0] op_sel_hi:[1,0]
    v_pk_mul_f32 v[170:171], v[170:171], v[16:17] op_sel:[0,0] op_sel_hi:[1,0]
    v_pk_fma_f32 v[160:161], v[48:49], v[18:19], v[160:161] op_sel:[0,0,0] op_sel_hi:[1,0,1]
    v_pk_fma_f32 v[162:163], v[50:51], v[18:19], v[162:163] op_sel:[0,0,0] op_sel_hi:[1,0,1]
    v_pk_fma_f32 v[168:169], v[52:53], v[18:19], v[168:169] op_sel:[0,0,0] op_sel_hi:[1,0,1]
    v_pk_fma_f32 v[170:171], v[54:55], v[18:19], v[170:171] op_sel:[0,0,0] op_sel_hi:[1,0,1]
    v_cvt_pk_bf16_f32 v56, v160, v161
    v_cvt_pk_bf16_f32 v57, v162, v163
    v_cvt_pk_bf16_f32 v58, v168, v169
    v_cvt_pk_bf16_f32 v59, v170, v171
    v_lshlrev_b32 v112, 16, v104
    v_and_b32 v113, 0xffff0000, v104
    v_lshlrev_b32 v114, 16, v105
    v_and_b32 v115, 0xffff0000, v105
    v_lshlrev_b32 v116, 16, v108
    v_and_b32 v117, 0xffff0000, v108
    v_lshlrev_b32 v118, 16, v109
    v_and_b32 v119, 0xffff0000, v109
    v_pk_mul_f32 v[176:177], v[176:177], v[16:17] op_sel:[0,0] op_sel_hi:[1,0]
    v_pk_mul_f32 v[178:179], v[178:179], v[16:17] op_sel:[0,0] op_sel_hi:[1,0]
    v_pk_mul_f32 v[184:185], v[184:185], v[16:17] op_sel:[0,0] op_sel_hi:[1,0]
    v_pk_mul_f32 v[186:187], v[186:187], v[16:17] op_sel:[0,0] op_sel_hi:[1,0]
    v_pk_fma_f32 v[176:177], v[112:113], v[18:19], v[176:177] op_sel:[0,0,0] op_sel_hi:[1,0,1]
    v_pk_fma_f32 v[178:179], v[114:115], v[18:19], v[178:179] op_sel:[0,0,0] op_sel_hi:[1,0,1]
    v_pk_fma_f32 v[184:185], v[116:117], v[18:19], v[184:185] op_sel:[0,0,0] op_sel_hi:[1,0,1]
    v_pk_fma_f32 v[186:187], v[118:119], v[18:19], v[186:187] op_sel:[0,0,0] op_sel_hi:[1,0,1]
    v_cvt_pk_bf16_f32 v60, v176, v177
    v_cvt_pk_bf16_f32 v61, v178, v179
    v_cvt_pk_bf16_f32 v62, v184, v185
    v_cvt_pk_bf16_f32 v63, v186, v187
    v_permlane16_swap_b32 v56, v58
    v_permlane16_swap_b32 v57, v59
    s_nop 0
    v_permlane16_swap_b32 v60, v62
    v_permlane16_swap_b32 v61, v63
    v_mov_b32 v64, v56
    v_mov_b32 v65, v57
    v_mov_b32 v66, v58
    v_mov_b32 v67, v59
    v_mov_b32_dpp v56, v60 row_ror:8 row_mask:0xf bank_mask:0xc
    v_mov_b32_dpp v57, v61 row_ror:8 row_mask:0xf bank_mask:0xc
    v_mov_b32_dpp v58, v62 row_ror:8 row_mask:0xf bank_mask:0xc
    v_mov_b32_dpp v59, v63 row_ror:8 row_mask:0xf bank_mask:0xc
    v_mov_b32_dpp v60, v64 row_ror:8 row_mask:0xf bank_mask:0x3
    v_mov_b32_dpp v61, v65 row_ror:8 row_mask:0xf bank_mask:0x3
    v_mov_b32_dpp v62, v66 row_ror:8 row_mask:0xf bank_mask:0x3
    v_mov_b32_dpp v63, v67 row_ror:8 row_mask:0xf bank_mask:0x3
    buffer_store_dwordx4 v[56:59], v14, s[16:19], s72 offen offset:128
    buffer_store_dwordx4 v[60:63], v14, s[16:19], s73 offen offset:128
    v_lshlrev_b32 v48, 16, v98
    v_and_b32 v49, 0xffff0000, v98
    v_lshlrev_b32 v50, 16, v99
    v_and_b32 v51, 0xffff0000, v99
    v_lshlrev_b32 v52, 16, v102
    v_and_b32 v53, 0xffff0000, v102
    v_lshlrev_b32 v54, 16, v103
    v_and_b32 v55, 0xffff0000, v103
    v_pk_mul_f32 v[164:165], v[164:165], v[16:17] op_sel:[0,1] op_sel_hi:[1,1]
    v_pk_mul_f32 v[166:167], v[166:167], v[16:17] op_sel:[0,1] op_sel_hi:[1,1]
    v_pk_mul_f32 v[172:173], v[172:173], v[16:17] op_sel:[0,1] op_sel_hi:[1,1]
    v_pk_mul_f32 v[174:175], v[174:175], v[16:17] op_sel:[0,1] op_sel_hi:[1,1]
    v_pk_fma_f32 v[164:165], v[48:49], v[18:19], v[164:165] op_sel:[0,1,0] op_sel_hi:[1,1,1]
    v_pk_fma_f32 v[166:167], v[50:51], v[18:19], v[166:167] op_sel:[0,1,0] op_sel_hi:[1,1,1]
    v_pk_fma_f32 v[172:173], v[52:53], v[18:19], v[172:173] op_sel:[0,1,0] op_sel_hi:[1,1,1]
    v_pk_fma_f32 v[174:175], v[54:55], v[18:19], v[174:175] op_sel:[0,1,0] op_sel_hi:[1,1,1]
    v_cvt_pk_bf16_f32 v68, v164, v165
    v_cvt_pk_bf16_f32 v69, v166, v167
    v_cvt_pk_bf16_f32 v70, v172, v173
    v_cvt_pk_bf16_f32 v71, v174, v175
    v_lshlrev_b32 v112, 16, v106
    v_and_b32 v113, 0xffff0000, v106
    v_lshlrev_b32 v114, 16, v107
    v_and_b32 v115, 0xffff0000, v107
    v_lshlrev_b32 v116, 16, v110
    v_and_b32 v117, 0xffff0000, v110
    v_lshlrev_b32 v118, 16, v111
    v_and_b32 v119, 0xffff0000, v111
    v_pk_mul_f32 v[180:181], v[180:181], v[16:17] op_sel:[0,1] op_sel_hi:[1,1]
    v_pk_mul_f32 v[182:183], v[182:183], v[16:17] op_sel:[0,1] op_sel_hi:[1,1]
    v_pk_mul_f32 v[188:189], v[188:189], v[16:17] op_sel:[0,1] op_sel_hi:[1,1]
    v_pk_mul_f32 v[190:191], v[190:191], v[16:17] op_sel:[0,1] op_sel_hi:[1,1]
    v_pk_fma_f32 v[180:181], v[112:113], v[18:19], v[180:181] op_sel:[0,1,0] op_sel_hi:[1,1,1]
    v_pk_fma_f32 v[182:183], v[114:115], v[18:19], v[182:183] op_sel:[0,1,0] op_sel_hi:[1,1,1]
    v_pk_fma_f32 v[188:189], v[116:117], v[18:19], v[188:189] op_sel:[0,1,0] op_sel_hi:[1,1,1]
    v_pk_fma_f32 v[190:191], v[118:119], v[18:19], v[190:191] op_sel:[0,1,0] op_sel_hi:[1,1,1]
    v_cvt_pk_bf16_f32 v72, v180, v181
    v_cvt_pk_bf16_f32 v73, v182, v183
    v_cvt_pk_bf16_f32 v74, v188, v189
    v_cvt_pk_bf16_f32 v75, v190, v191
    v_permlane16_swap_b32 v68, v70
    v_permlane16_swap_b32 v69, v71
    s_nop 0
    v_permlane16_swap_b32 v72, v74
    v_permlane16_swap_b32 v73, v75
    v_mov_b32 v76, v68
    v_mov_b32 v77, v69
    v_mov_b32 v78, v70
    v_mov_b32 v79, v71
    v_mov_b32_dpp v68, v72 row_ror:8 row_mask:0xf bank_mask:0xc
    v_mov_b32_dpp v69, v73 row_ror:8 row_mask:0xf bank_mask:0xc
    v_mov_b32_dpp v70, v74 row_ror:8 row_mask:0xf bank_mask:0xc
    v_mov_b32_dpp v71, v75 row_ror:8 row_mask:0xf bank_mask:0xc
    v_mov_b32_dpp v72, v76 row_ror:8 row_mask:0xf bank_mask:0x3
    v_mov_b32_dpp v73, v77 row_ror:8 row_mask:0xf bank_mask:0x3
    v_mov_b32_dpp v74, v78 row_ror:8 row_mask:0xf bank_mask:0x3
    v_mov_b32_dpp v75, v79 row_ror:8 row_mask:0xf bank_mask:0x3
    buffer_store_dwordx4 v[68:71], v14, s[16:19], s74 offen offset:128
    buffer_store_dwordx4 v[72:75], v14, s[16:19], s75 offen offset:128
L_end:
L_done:
    s_endpgm
L_rare_0:
    s_mov_b32 s28, 1
    s_call_b64 s[36:37], L_rescale
    s_branch L_back_0
L_rare_1:
    s_mov_b32 s28, 0
    s_call_b64 s[36:37], L_rescale
    s_branch L_back_1
L_rare_2:
    s_mov_b32 s28, 1
    s_call_b64 s[36:37], L_rescale
    s_branch L_back_2
L_rare_3:
    s_mov_b32 s28, 0
    s_call_b64 s[36:37], L_rescale
    s_branch L_back_3
L_rare_4:
    s_mov_b32 s28, 1
    s_call_b64 s[36:37], L_rescale
    s_branch L_back_4
L_rare_5:
    s_mov_b32 s28, 0
    s_call_b64 s[36:37], L_rescale
    s_branch L_back_5
L_rare_6:
    s_mov_b32 s28, 1
    s_call_b64 s[36:37], L_rescale
    s_branch L_back_6
L_rescale:
    s_nop 15
    v_mov_b32 v44, v42
    v_mov_b32 v45, v43
    s_nop 1
    v_permlane32_swap_b32 v42, v44
    v_permlane32_swap_b32 v43, v45
    s_nop 1
    v_max_f32 v42, v42, v44
    v_max_f32 v43, v43, v45
    v_mov_b32 v44, v42
    v_mov_b32 v45, v43
    s_nop 1
    v_permlane16_swap_b32 v42, v44
    v_permlane16_swap_b32 v43, v45
    s_nop 1
    v_max_f32 v42, v42, v44
    v_max_f32 v43, v43, v45
    v_ceil_f32 v42, v42
    v_max_f32 v42, 0, v42
    v_exp_f32 v44, -v42
    v_add_f32 v38, v38, v42
    v_ceil_f32 v43, v43
    v_max_f32 v43, 0, v43
    v_exp_f32 v45, -v43
    v_add_f32 v39, v39, v43
    v_sub_f32 v244, v244, v42
    v_sub_f32 v245, v245, v42
    v_sub_f32 v246, v246, v42
    v_sub_f32 v247, v247, v42
    v_sub_f32 v248, v248, v43
    v_sub_f32 v249, v249, v43
    v_sub_f32 v250, v250, v43
    v_sub_f32 v251, v251, v43
    s_cmp_eq_u32 s28, 0
    s_cbranch_scc1 L_fix0
    v_sub_f32 v80, v80, v42
    v_sub_f32 v81, v81, v42
    v_sub_f32 v82, v82, v42
    v_sub_f32 v83, v83, v42
    v_sub_f32 v84, v84, v43
    v_sub_f32 v85, v85, v43
    v_sub_f32 v86, v86, v43
    v_sub_f32 v87, v87, v43
    v_sub_f32 v88, v88, v42
    v_sub_f32 v89, v89, v42
    v_sub_f32 v90, v90, v42
    v_sub_f32 v91, v91, v42
    v_sub_f32 v92, v92, v43
    v_sub_f32 v93, v93, v43
    v_sub_f32 v94, v94, v43
    v_sub_f32 v95, v95, v43
    v_sub_f32 v96, v96, v42
    v_sub_f32 v97, v97, v42
    v_sub_f32 v98, v98, v42
    v_sub_f32 v99, v99, v42
    v_sub_f32 v100, v100, v43
    v_sub_f32 v101, v101, v43
    v_sub_f32 v102, v102, v43
    v_sub_f32 v103, v103, v43
    v_sub_f32 v104, v104, v42
    v_sub_f32 v105, v105, v42
    v_sub_f32 v106, v106, v42
    v_sub_f32 v107, v107, v42
    v_sub_f32 v108, v108, v43
    v_sub_f32 v109, v109, v43
    v_sub_f32 v110, v110, v43
    v_sub_f32 v111, v111, v43
    s_cmp_eq_u32 s28, 1
    s_cbranch_scc1 L_fixed
L_fix0:
    v_sub_f32 v48, v48, v42
    v_sub_f32 v49, v49, v42
    v_sub_f32 v50, v50, v42
    v_sub_f32 v51, v51, v42
    v_sub_f32 v52, v52, v43
    v_sub_f32 v53, v53, v43
    v_sub_f32 v54, v54, v43
    v_sub_f32 v55, v55, v43
    v_sub_f32 v56, v56, v42
    v_sub_f32 v57, v57, v42
    v_sub_f32 v58, v58, v42
    v_sub_f32 v59, v59, v42
    v_sub_f32 v60, v60, v43
    v_sub_f32 v61, v61, v43
    v_sub_f32 v62, v62, v43
    v_sub_f32 v63, v63, v43
    v_sub_f32 v64, v64, v42
    v_sub_f32 v65, v65, v42
    v_sub_f32 v66, v66, v42
    v_sub_f32 v67, v67, v42
    v_sub_f32 v68, v68, v43
    v_sub_f32 v69, v69, v43
    v_sub_f32 v70, v70, v43
    v_sub_f32 v71, v71, v43
    v_sub_f32 v72, v72, v42
    v_sub_f32 v73, v73, v42
    v_sub_f32 v74, v74, v42
    v_sub_f32 v75, v75, v42
    v_sub_f32 v76, v76, v43
    v_sub_f32 v77, v77, v43
    v_sub_f32 v78, v78, v43
    v_sub_f32 v79, v79, v43
L_fixed:
    v_accvgpr_read_b32 v46, a196
    v_mul_f32 v46, v46, v44
    v_accvgpr_write_b32 a196, v46
    v_accvgpr_read_b32 v46, a197
    v_mul_f32 v46, v46, v44
    v_accvgpr_write_b32 a197, v46
    v_accvgpr_read_b32 v46, a198
    v_mul_f32 v46, v46, v44
    v_accvgpr_write_b32 a198, v46
    v_accvgpr_read_b32 v46, a199
    v_mul_f32 v46, v46, v44
    v_accvgpr_write_b32 a199, v46
    v_accvgpr_read_b32 v46, a200
    v_mul_f32 v46, v46, v45
    v_accvgpr_write_b32 a200, v46
    v_accvgpr_read_b32 v46, a201
    v_mul_f32 v46, v46, v45
    v_accvgpr_write_b32 a201, v46
    v_accvgpr_read_b32 v46, a202
    v_mul_f32 v46, v46, v45
    v_accvgpr_write_b32 a202, v46
    v_accvgpr_read_b32 v46, a203
    v_mul_f32 v46, v46, v45
    v_accvgpr_write_b32 a203, v46
    v_lshlrev_b32 v46, 16, v112
    v_and_b32 v47, 0xffff0000, v112
    v_mul_f32 v46, v46, v44
    v_mul_f32 v47, v47, v44
    v_cvt_pk_bf16_f32 v112, v46, v47
    v_lshlrev_b32 v46, 16, v113
    v_and_b32 v47, 0xffff0000, v113
    v_mul_f32 v46, v46, v44
    v_mul_f32 v47, v47, v44
    v_cvt_pk_bf16_f32 v113, v46, v47
    v_lshlrev_b32 v46, 16, v114
    v_and_b32 v47, 0xffff0000, v114
    v_mul_f32 v46, v46, v44
    v_mul_f32 v47, v47, v44
    v_cvt_pk_bf16_f32 v114, v46, v47
    v_lshlrev_b32 v46, 16, v115
    v_and_b32 v47, 0xffff0000, v115
    v_mul_f32 v46, v46, v44
    v_mul_f32 v47, v47, v44
    v_cvt_pk_bf16_f32 v115, v46, v47
    v_lshlrev_b32 v46, 16, v116
    v_and_b32 v47, 0xffff0000, v116
    v_mul_f32 v46, v46, v45
    v_mul_f32 v47, v47, v45
    v_cvt_pk_bf16_f32 v116, v46, v47
    v_lshlrev_b32 v46, 16, v117
    v_and_b32 v47, 0xffff0000, v117
    v_mul_f32 v46, v46, v45
    v_mul_f32 v47, v47, v45
    v_cvt_pk_bf16_f32 v117, v46, v47
    v_lshlrev_b32 v46, 16, v118
    v_and_b32 v47, 0xffff0000, v118
    v_mul_f32 v46, v46, v45
    v_mul_f32 v47, v47, v45
    v_cvt_pk_bf16_f32 v118, v46, v47
    v_lshlrev_b32 v46, 16, v119
    v_and_b32 v47, 0xffff0000, v119
    v_mul_f32 v46, v46, v45
    v_mul_f32 v47, v47, v45
    v_cvt_pk_bf16_f32 v119, v46, v47
    v_lshlrev_b32 v46, 16, v120
    v_and_b32 v47, 0xffff0000, v120
    v_mul_f32 v46, v46, v44
    v_mul_f32 v47, v47, v44
    v_cvt_pk_bf16_f32 v120, v46, v47
    v_lshlrev_b32 v46, 16, v121
    v_and_b32 v47, 0xffff0000, v121
    v_mul_f32 v46, v46, v44
    v_mul_f32 v47, v47, v44
    v_cvt_pk_bf16_f32 v121, v46, v47
    v_lshlrev_b32 v46, 16, v122
    v_and_b32 v47, 0xffff0000, v122
    v_mul_f32 v46, v46, v44
    v_mul_f32 v47, v47, v44
    v_cvt_pk_bf16_f32 v122, v46, v47
    v_lshlrev_b32 v46, 16, v123
    v_and_b32 v47, 0xffff0000, v123
    v_mul_f32 v46, v46, v44
    v_mul_f32 v47, v47, v44
    v_cvt_pk_bf16_f32 v123, v46, v47
    v_lshlrev_b32 v46, 16, v124
    v_and_b32 v47, 0xffff0000, v124
    v_mul_f32 v46, v46, v45
    v_mul_f32 v47, v47, v45
    v_cvt_pk_bf16_f32 v124, v46, v47
    v_lshlrev_b32 v46, 16, v125
    v_and_b32 v47, 0xffff0000, v125
    v_mul_f32 v46, v46, v45
    v_mul_f32 v47, v47, v45
    v_cvt_pk_bf16_f32 v125, v46, v47
    v_lshlrev_b32 v46, 16, v126
    v_and_b32 v47, 0xffff0000, v126
    v_mul_f32 v46, v46, v45
    v_mul_f32 v47, v47, v45
    v_cvt_pk_bf16_f32 v126, v46, v47
    v_lshlrev_b32 v46, 16, v127
    v_and_b32 v47, 0xffff0000, v127
    v_mul_f32 v46, v46, v45
    v_mul_f32 v47, v47, v45
    v_cvt_pk_bf16_f32 v127, v46, v47
    v_lshlrev_b32 v46, 16, v192
    v_and_b32 v47, 0xffff0000, v192
    v_mul_f32 v46, v46, v44
    v_mul_f32 v47, v47, v44
    v_cvt_pk_bf16_f32 v192, v46, v47
    v_lshlrev_b32 v46, 16, v193
    v_and_b32 v47, 0xffff0000, v193
    v_mul_f32 v46, v46, v44
    v_mul_f32 v47, v47, v44
    v_cvt_pk_bf16_f32 v193, v46, v47
    v_lshlrev_b32 v46, 16, v194
    v_and_b32 v47, 0xffff0000, v194
    v_mul_f32 v46, v46, v44
    v_mul_f32 v47, v47, v44
    v_cvt_pk_bf16_f32 v194, v46, v47
    v_lshlrev_b32 v46, 16, v195
    v_and_b32 v47, 0xffff0000, v195
    v_mul_f32 v46, v46, v44
    v_mul_f32 v47, v47, v44
    v_cvt_pk_bf16_f32 v195, v46, v47
    v_lshlrev_b32 v46, 16, v196
    v_and_b32 v47, 0xffff0000, v196
    v_mul_f32 v46, v46, v45
    v_mul_f32 v47, v47, v45
    v_cvt_pk_bf16_f32 v196, v46, v47
    v_lshlrev_b32 v46, 16, v197
    v_and_b32 v47, 0xffff0000, v197
    v_mul_f32 v46, v46, v45
    v_mul_f32 v47, v47, v45
    v_cvt_pk_bf16_f32 v197, v46, v47
    v_lshlrev_b32 v46, 16, v198
    v_and_b32 v47, 0xffff0000, v198
    v_mul_f32 v46, v46, v45
    v_mul_f32 v47, v47, v45
    v_cvt_pk_bf16_f32 v198, v46, v47
    v_lshlrev_b32 v46, 16, v199
    v_and_b32 v47, 0xffff0000, v199
    v_mul_f32 v46, v46, v45
    v_mul_f32 v47, v47, v45
    v_cvt_pk_bf16_f32 v199, v46, v47
    v_lshlrev_b32 v46, 16, v200
    v_and_b32 v47, 0xffff0000, v200
    v_mul_f32 v46, v46, v44
    v_mul_f32 v47, v47, v44
    v_cvt_pk_bf16_f32 v200, v46, v47
    v_lshlrev_b32 v46, 16, v201
    v_and_b32 v47, 0xffff0000, v201
    v_mul_f32 v46, v46, v44
    v_mul_f32 v47, v47, v44
    v_cvt_pk_bf16_f32 v201, v46, v47
    v_lshlrev_b32 v46, 16, v202
    v_and_b32 v47, 0xffff0000, v202
    v_mul_f32 v46, v46, v44
    v_mul_f32 v47, v47, v44
    v_cvt_pk_bf16_f32 v202, v46, v47
    v_lshlrev_b32 v46, 16, v203
    v_and_b32 v47, 0xffff0000, v203
    v_mul_f32 v46, v46, v44
    v_mul_f32 v47, v47, v44
    v_cvt_pk_bf16_f32 v203, v46, v47
    v_lshlrev_b32 v46, 16, v204
    v_and_b32 v47, 0xffff0000, v204
    v_mul_f32 v46, v46, v45
    v_mul_f32 v47, v47, v45
    v_cvt_pk_bf16_f32 v204, v46, v47
    v_lshlrev_b32 v46, 16, v205
    v_and_b32 v47, 0xffff0000, v205
    v_mul_f32 v46, v46, v45
    v_mul_f32 v47, v47, v45
    v_cvt_pk_bf16_f32 v205, v46, v47
    v_lshlrev_b32 v46, 16, v206
    v_and_b32 v47, 0xffff0000, v206
    v_mul_f32 v46, v46, v45
    v_mul_f32 v47, v47, v45
    v_cvt_pk_bf16_f32 v206, v46, v47
    v_lshlrev_b32 v46, 16, v207
    v_and_b32 v47, 0xffff0000, v207
    v_mul_f32 v46, v46, v45
    v_mul_f32 v47, v47, v45
    v_cvt_pk_bf16_f32 v207, v46, v47
    v_lshlrev_b32 v46, 16, v208
    v_and_b32 v47, 0xffff0000, v208
    v_mul_f32 v46, v46, v44
    v_mul_f32 v47, v47, v44
    v_cvt_pk_bf16_f32 v208, v46, v47
    v_lshlrev_b32 v46, 16, v209
    v_and_b32 v47, 0xffff0000, v209
    v_mul_f32 v46, v46, v44
    v_mul_f32 v47, v47, v44
    v_cvt_pk_bf16_f32 v209, v46, v47
    v_lshlrev_b32 v46, 16, v210
    v_and_b32 v47, 0xffff0000, v210
    v_mul_f32 v46, v46, v44
    v_mul_f32 v47, v47, v44
    v_cvt_pk_bf16_f32 v210, v46, v47
    v_lshlrev_b32 v46, 16, v211
    v_and_b32 v47, 0xffff0000, v211
    v_mul_f32 v46, v46, v44
    v_mul_f32 v47, v47, v44
    v_cvt_pk_bf16_f32 v211, v46, v47
    v_lshlrev_b32 v46, 16, v212
    v_and_b32 v47, 0xffff0000, v212
    v_mul_f32 v46, v46, v45
    v_mul_f32 v47, v47, v45
    v_cvt_pk_bf16_f32 v212, v46, v47
    v_lshlrev_b32 v46, 16, v213
    v_and_b32 v47, 0xffff0000, v213
    v_mul_f32 v46, v46, v45
    v_mul_f32 v47, v47, v45
    v_cvt_pk_bf16_f32 v213, v46, v47
    v_lshlrev_b32 v46, 16, v214
    v_and_b32 v47, 0xffff0000, v214
    v_mul_f32 v46, v46, v45
    v_mul_f32 v47, v47, v45
    v_cvt_pk_bf16_f32 v214, v46, v47
    v_lshlrev_b32 v46, 16, v215
    v_and_b32 v47, 0xffff0000, v215
    v_mul_f32 v46, v46, v45
    v_mul_f32 v47, v47, v45
    v_cvt_pk_bf16_f32 v215, v46, v47
    v_lshlrev_b32 v46, 16, v216
    v_and_b32 v47, 0xffff0000, v216
    v_mul_f32 v46, v46, v44
    v_mul_f32 v47, v47, v44
    v_cvt_pk_bf16_f32 v216, v46, v47
    v_lshlrev_b32 v46, 16, v217
    v_and_b32 v47, 0xffff0000, v217
    v_mul_f32 v46, v46, v44
    v_mul_f32 v47, v47, v44
    v_cvt_pk_bf16_f32 v217, v46, v47
    v_lshlrev_b32 v46, 16, v218
    v_and_b32 v47, 0xffff0000, v218
    v_mul_f32 v46, v46, v44
    v_mul_f32 v47, v47, v44
    v_cvt_pk_bf16_f32 v218, v46, v47
    v_lshlrev_b32 v46, 16, v219
    v_and_b32 v47, 0xffff0000, v219
    v_mul_f32 v46, v46, v44
    v_mul_f32 v47, v47, v44
    v_cvt_pk_bf16_f32 v219, v46, v47
    v_lshlrev_b32 v46, 16, v220
    v_and_b32 v47, 0xffff0000, v220
    v_mul_f32 v46, v46, v45
    v_mul_f32 v47, v47, v45
    v_cvt_pk_bf16_f32 v220, v46, v47
    v_lshlrev_b32 v46, 16, v221
    v_and_b32 v47, 0xffff0000, v221
    v_mul_f32 v46, v46, v45
    v_mul_f32 v47, v47, v45
    v_cvt_pk_bf16_f32 v221, v46, v47
    v_lshlrev_b32 v46, 16, v222
    v_and_b32 v47, 0xffff0000, v222
    v_mul_f32 v46, v46, v45
    v_mul_f32 v47, v47, v45
    v_cvt_pk_bf16_f32 v222, v46, v47
    v_lshlrev_b32 v46, 16, v223
    v_and_b32 v47, 0xffff0000, v223
    v_mul_f32 v46, v46, v45
    v_mul_f32 v47, v47, v45
    v_cvt_pk_bf16_f32 v223, v46, v47
    v_lshlrev_b32 v46, 16, v224
    v_and_b32 v47, 0xffff0000, v224
    v_mul_f32 v46, v46, v44
    v_mul_f32 v47, v47, v44
    v_cvt_pk_bf16_f32 v224, v46, v47
    v_lshlrev_b32 v46, 16, v225
    v_and_b32 v47, 0xffff0000, v225
    v_mul_f32 v46, v46, v44
    v_mul_f32 v47, v47, v44
    v_cvt_pk_bf16_f32 v225, v46, v47
    v_lshlrev_b32 v46, 16, v226
    v_and_b32 v47, 0xffff0000, v226
    v_mul_f32 v46, v46, v44
    v_mul_f32 v47, v47, v44
    v_cvt_pk_bf16_f32 v226, v46, v47
    v_lshlrev_b32 v46, 16, v227
    v_and_b32 v47, 0xffff0000, v227
    v_mul_f32 v46, v46, v44
    v_mul_f32 v47, v47, v44
    v_cvt_pk_bf16_f32 v227, v46, v47
    v_lshlrev_b32 v46, 16, v228
    v_and_b32 v47, 0xffff0000, v228
    v_mul_f32 v46, v46, v45
    v_mul_f32 v47, v47, v45
    v_cvt_pk_bf16_f32 v228, v46, v47
    v_lshlrev_b32 v46, 16, v229
    v_and_b32 v47, 0xffff0000, v229
    v_mul_f32 v46, v46, v45
    v_mul_f32 v47, v47, v45
    v_cvt_pk_bf16_f32 v229, v46, v47
    v_lshlrev_b32 v46, 16, v230
    v_and_b32 v47, 0xffff0000, v230
    v_mul_f32 v46, v46, v45
    v_mul_f32 v47, v47, v45
    v_cvt_pk_bf16_f32 v230, v46, v47
    v_lshlrev_b32 v46, 16, v231
    v_and_b32 v47, 0xffff0000, v231
    v_mul_f32 v46, v46, v45
    v_mul_f32 v47, v47, v45
    v_cvt_pk_bf16_f32 v231, v46, v47
    v_lshlrev_b32 v46, 16, v232
    v_and_b32 v47, 0xffff0000, v232
    v_mul_f32 v46, v46, v44
    v_mul_f32 v47, v47, v44
    v_cvt_pk_bf16_f32 v232, v46, v47
    v_lshlrev_b32 v46, 16, v233
    v_and_b32 v47, 0xffff0000, v233
    v_mul_f32 v46, v46, v44
    v_mul_f32 v47, v47, v44
    v_cvt_pk_bf16_f32 v233, v46, v47
    v_lshlrev_b32 v46, 16, v234
    v_and_b32 v47, 0xffff0000, v234
    v_mul_f32 v46, v46, v44
    v_mul_f32 v47, v47, v44
    v_cvt_pk_bf16_f32 v234, v46, v47
    v_lshlrev_b32 v46, 16, v235
    v_and_b32 v47, 0xffff0000, v235
    v_mul_f32 v46, v46, v44
    v_mul_f32 v47, v47, v44
    v_cvt_pk_bf16_f32 v235, v46, v47
    v_lshlrev_b32 v46, 16, v236
    v_and_b32 v47, 0xffff0000, v236
    v_mul_f32 v46, v46, v45
    v_mul_f32 v47, v47, v45
    v_cvt_pk_bf16_f32 v236, v46, v47
    v_lshlrev_b32 v46, 16, v237
    v_and_b32 v47, 0xffff0000, v237
    v_mul_f32 v46, v46, v45
    v_mul_f32 v47, v47, v45
    v_cvt_pk_bf16_f32 v237, v46, v47
    v_lshlrev_b32 v46, 16, v238
    v_and_b32 v47, 0xffff0000, v238
    v_mul_f32 v46, v46, v45
    v_mul_f32 v47, v47, v45
    v_cvt_pk_bf16_f32 v238, v46, v47
    v_lshlrev_b32 v46, 16, v239
    v_and_b32 v47, 0xffff0000, v239
    v_mul_f32 v46, v46, v45
    v_mul_f32 v47, v47, v45
    v_cvt_pk_bf16_f32 v239, v46, v47
    v_mul_f32 v128, v128, v44
    v_mul_f32 v129, v129, v44
    v_mul_f32 v130, v130, v44
    v_mul_f32 v131, v131, v44
    v_mul_f32 v132, v132, v45
    v_mul_f32 v133, v133, v45
    v_mul_f32 v134, v134, v45
    v_mul_f32 v135, v135, v45
    v_mul_f32 v136, v136, v44
    v_mul_f32 v137, v137, v44
    v_mul_f32 v138, v138, v44
    v_mul_f32 v139, v139, v44
    v_mul_f32 v140, v140, v45
    v_mul_f32 v141, v141, v45
    v_mul_f32 v142, v142, v45
    v_mul_f32 v143, v143, v45
    v_mul_f32 v144, v144, v44
    v_mul_f32 v145, v145, v44
    v_mul_f32 v146, v146, v44
    v_mul_f32 v147, v147, v44
    v_mul_f32 v148, v148, v45
    v_mul_f32 v149, v149, v45
    v_mul_f32 v150, v150, v45
    v_mul_f32 v151, v151, v45
    v_mul_f32 v152, v152, v44
    v_mul_f32 v153, v153, v44
    v_mul_f32 v154, v154, v44
    v_mul_f32 v155, v155, v44
    v_mul_f32 v156, v156, v45
    v_mul_f32 v157, v157, v45
    v_mul_f32 v158, v158, v45
    v_mul_f32 v159, v159, v45
    v_mul_f32 v160, v160, v44
    v_mul_f32 v161, v161, v44
    v_mul_f32 v162, v162, v44
    v_mul_f32 v163, v163, v44
    v_mul_f32 v164, v164, v45
    v_mul_f32 v165, v165, v45
    v_mul_f32 v166, v166, v45
    v_mul_f32 v167, v167, v45
    v_mul_f32 v168, v168, v44
    v_mul_f32 v169, v169, v44
    v_mul_f32 v170, v170, v44
    v_mul_f32 v171, v171, v44
    v_mul_f32 v172, v172, v45
    v_mul_f32 v173, v173, v45
    v_mul_f32 v174, v174, v45
    v_mul_f32 v175, v175, v45
    v_mul_f32 v176, v176, v44
    v_mul_f32 v177, v177, v44
    v_mul_f32 v178, v178, v44
    v_mul_f32 v179, v179, v44
    v_mul_f32 v180, v180, v45
    v_mul_f32 v181, v181, v45
    v_mul_f32 v182, v182, v45
    v_mul_f32 v183, v183, v45
    v_mul_f32 v184, v184, v44
    v_mul_f32 v185, v185, v44
    v_mul_f32 v186, v186, v44
    v_mul_f32 v187, v187, v44
    v_mul_f32 v188, v188, v45
    v_mul_f32 v189, v189, v45
    v_mul_f32 v190, v190, v45
    v_mul_f32 v191, v191, v45
    v_accvgpr_read_b32 v46, a0
    v_accvgpr_read_b32 v47, a1
    v_mul_f32 v46, v46, v44
    v_mul_f32 v47, v47, v44
    v_accvgpr_write_b32 a0, v46
    v_accvgpr_write_b32 a1, v47
    v_accvgpr_read_b32 v46, a2
    v_accvgpr_read_b32 v47, a3
    v_mul_f32 v46, v46, v44
    v_mul_f32 v47, v47, v44
    v_accvgpr_write_b32 a2, v46
    v_accvgpr_write_b32 a3, v47
    v_accvgpr_read_b32 v46, a4
    v_accvgpr_read_b32 v47, a5
    v_mul_f32 v46, v46, v45
    v_mul_f32 v47, v47, v45
    v_accvgpr_write_b32 a4, v46
    v_accvgpr_write_b32 a5, v47
    v_accvgpr_read_b32 v46, a6
    v_accvgpr_read_b32 v47, a7
    v_mul_f32 v46, v46, v45
    v_mul_f32 v47, v47, v45
    v_accvgpr_write_b32 a6, v46
    v_accvgpr_write_b32 a7, v47
    v_accvgpr_read_b32 v46, a8
    v_accvgpr_read_b32 v47, a9
    v_mul_f32 v46, v46, v44
    v_mul_f32 v47, v47, v44
    v_accvgpr_write_b32 a8, v46
    v_accvgpr_write_b32 a9, v47
    v_accvgpr_read_b32 v46, a10
    v_accvgpr_read_b32 v47, a11
    v_mul_f32 v46, v46, v44
    v_mul_f32 v47, v47, v44
    v_accvgpr_write_b32 a10, v46
    v_accvgpr_write_b32 a11, v47
    v_accvgpr_read_b32 v46, a12
    v_accvgpr_read_b32 v47, a13
    v_mul_f32 v46, v46, v45
    v_mul_f32 v47, v47, v45
    v_accvgpr_write_b32 a12, v46
    v_accvgpr_write_b32 a13, v47
    v_accvgpr_read_b32 v46, a14
    v_accvgpr_read_b32 v47, a15
    v_mul_f32 v46, v46, v45
    v_mul_f32 v47, v47, v45
    v_accvgpr_write_b32 a14, v46
    v_accvgpr_write_b32 a15, v47
    v_accvgpr_read_b32 v46, a16
    v_accvgpr_read_b32 v47, a17
    v_mul_f32 v46, v46, v44
    v_mul_f32 v47, v47, v44
    v_accvgpr_write_b32 a16, v46
    v_accvgpr_write_b32 a17, v47
    v_accvgpr_read_b32 v46, a18
    v_accvgpr_read_b32 v47, a19
    v_mul_f32 v46, v46, v44
    v_mul_f32 v47, v47, v44
    v_accvgpr_write_b32 a18, v46
    v_accvgpr_write_b32 a19, v47
    v_accvgpr_read_b32 v46, a20
    v_accvgpr_read_b32 v47, a21
    v_mul_f32 v46, v46, v45
    v_mul_f32 v47, v47, v45
    v_accvgpr_write_b32 a20, v46
    v_accvgpr_write_b32 a21, v47
    v_accvgpr_read_b32 v46, a22
    v_accvgpr_read_b32 v47, a23
    v_mul_f32 v46, v46, v45
    v_mul_f32 v47, v47, v45
    v_accvgpr_write_b32 a22, v46
    v_accvgpr_write_b32 a23, v47
    v_accvgpr_read_b32 v46, a24
    v_accvgpr_read_b32 v47, a25
    v_mul_f32 v46, v46, v44
    v_mul_f32 v47, v47, v44
    v_accvgpr_write_b32 a24, v46
    v_accvgpr_write_b32 a25, v47
    v_accvgpr_read_b32 v46, a26
    v_accvgpr_read_b32 v47, a27
    v_mul_f32 v46, v46, v44
    v_mul_f32 v47, v47, v44
    v_accvgpr_write_b32 a26, v46
    v_accvgpr_write_b32 a27, v47
    v_accvgpr_read_b32 v46, a28
    v_accvgpr_read_b32 v47, a29
    v_mul_f32 v46, v46, v45
    v_mul_f32 v47, v47, v45
    v_accvgpr_write_b32 a28, v46
    v_accvgpr_write_b32 a29, v47
    v_accvgpr_read_b32 v46, a30
    v_accvgpr_read_b32 v47, a31
    v_mul_f32 v46, v46, v45
    v_mul_f32 v47, v47, v45
    v_accvgpr_write_b32 a30, v46
    v_accvgpr_write_b32 a31, v47
    v_accvgpr_read_b32 v46, a32
    v_accvgpr_read_b32 v47, a33
    v_mul_f32 v46, v46, v44
    v_mul_f32 v47, v47, v44
    v_accvgpr_write_b32 a32, v46
    v_accvgpr_write_b32 a33, v47
    v_accvgpr_read_b32 v46, a34
    v_accvgpr_read_b32 v47, a35
    v_mul_f32 v46, v46, v44
    v_mul_f32 v47, v47, v44
    v_accvgpr_write_b32 a34, v46
    v_accvgpr_write_b32 a35, v47
    v_accvgpr_read_b32 v46, a36
    v_accvgpr_read_b32 v47, a37
    v_mul_f32 v46, v46, v45
    v_mul_f32 v47, v47, v45
    v_accvgpr_write_b32 a36, v46
    v_accvgpr_write_b32 a37, v47
    v_accvgpr_read_b32 v46, a38
    v_accvgpr_read_b32 v47, a39
    v_mul_f32 v46, v46, v45
    v_mul_f32 v47, v47, v45
    v_accvgpr_write_b32 a38, v46
    v_accvgpr_write_b32 a39, v47
    v_accvgpr_read_b32 v46, a40
    v_accvgpr_read_b32 v47, a41
    v_mul_f32 v46, v46, v44
    v_mul_f32 v47, v47, v44
    v_accvgpr_write_b32 a40, v46
    v_accvgpr_write_b32 a41, v47
    v_accvgpr_read_b32 v46, a42
    v_accvgpr_read_b32 v47, a43
    v_mul_f32 v46, v46, v44
    v_mul_f32 v47, v47, v44
    v_accvgpr_write_b32 a42, v46
    v_accvgpr_write_b32 a43, v47
    v_accvgpr_read_b32 v46, a44
    v_accvgpr_read_b32 v47, a45
    v_mul_f32 v46, v46, v45
    v_mul_f32 v47, v47, v45
    v_accvgpr_write_b32 a44, v46
    v_accvgpr_write_b32 a45, v47
    v_accvgpr_read_b32 v46, a46
    v_accvgpr_read_b32 v47, a47
    v_mul_f32 v46, v46, v45
    v_mul_f32 v47, v47, v45
    v_accvgpr_write_b32 a46, v46
    v_accvgpr_write_b32 a47, v47
    v_accvgpr_read_b32 v46, a48
    v_accvgpr_read_b32 v47, a49
    v_mul_f32 v46, v46, v44
    v_mul_f32 v47, v47, v44
    v_accvgpr_write_b32 a48, v46
    v_accvgpr_write_b32 a49, v47
    v_accvgpr_read_b32 v46, a50
    v_accvgpr_read_b32 v47, a51
    v_mul_f32 v46, v46, v44
    v_mul_f32 v47, v47, v44
    v_accvgpr_write_b32 a50, v46
    v_accvgpr_write_b32 a51, v47
    v_accvgpr_read_b32 v46, a52
    v_accvgpr_read_b32 v47, a53
    v_mul_f32 v46, v46, v45
    v_mul_f32 v47, v47, v45
    v_accvgpr_write_b32 a52, v46
    v_accvgpr_write_b32 a53, v47
    v_accvgpr_read_b32 v46, a54
    v_accvgpr_read_b32 v47, a55
    v_mul_f32 v46, v46, v45
    v_mul_f32 v47, v47, v45
    v_accvgpr_write_b32 a54, v46
    v_accvgpr_write_b32 a55, v47
    v_accvgpr_read_b32 v46, a56
    v_accvgpr_read_b32 v47, a57
    v_mul_f32 v46, v46, v44
    v_mul_f32 v47, v47, v44
    v_accvgpr_write_b32 a56, v46
    v_accvgpr_write_b32 a57, v47
    v_accvgpr_read_b32 v46, a58
    v_accvgpr_read_b32 v47, a59
    v_mul_f32 v46, v46, v44
    v_mul_f32 v47, v47, v44
    v_accvgpr_write_b32 a58, v46
    v_accvgpr_write_b32 a59, v47
    v_accvgpr_read_b32 v46, a60
    v_accvgpr_read_b32 v47, a61
    v_mul_f32 v46, v46, v45
    v_mul_f32 v47, v47, v45
    v_accvgpr_write_b32 a60, v46
    v_accvgpr_write_b32 a61, v47
    v_accvgpr_read_b32 v46, a62
    v_accvgpr_read_b32 v47, a63
    v_mul_f32 v46, v46, v45
    v_mul_f32 v47, v47, v45
    v_accvgpr_write_b32 a62, v46
    v_accvgpr_write_b32 a63, v47
    s_nop 1
    s_setpc_b64 s[36:37]
L_codeend:
.section .rodata,"a"
.p2align 6
.amdhsa_kernel standalone__gqa_softmax__near_ridge_kernel
  .amdhsa_next_free_vgpr 460
  .amdhsa_next_free_sgpr 100
  .amdhsa_accum_offset 256
  .amdhsa_group_segment_fixed_size 0
  .amdhsa_kernarg_size 48
  .amdhsa_user_sgpr_count 2
  .amdhsa_user_sgpr_kernarg_segment_ptr 1
  .amdhsa_system_sgpr_workgroup_id_x 1
.end_amdhsa_kernel
```
